```python
import torch

def _softmax(x, axis=-1):
    return torch.softmax(x, dim=axis)
def _gelu(x):
    return torch.nn.functional.gelu(x, approximate="tanh")
def _silu(x):
    return torch.nn.functional.silu(x)
def _sigmoid(x):
    return torch.sigmoid(x)
def _layernorm(x, axis=-1, eps=1e-5):
    m = x.mean(dim=axis, keepdim=True)
    v = x.var(dim=axis, keepdim=True, unbiased=False)
    return (x - m) / torch.sqrt(v + eps)
def _scatter_add(tgt, idx, src, axis=0):
    return tgt.clone().index_add_(axis, idx, src)
def _segment_sum(src, seg, n):
    out = torch.zeros((n,) + src.shape[1:], dtype=src.dtype)
    return out.index_add_(0, seg, src)
def _pad(x, pw):
    flat = tuple(v for pair in reversed(pw) for v in pair)
    return torch.nn.functional.pad(x, flat)

kernel_name = 'interleave_layers__sliding_block_cached__dense_activation_gelu__decode'

def setup_inputs():

    _w = (lambda a: (lambda t: t.to(torch.bfloat16) if t.is_floating_point() else t)(torch.as_tensor(a)))
    def _A_setup():
        B, Sq, D = 1, 1, 512
        Hq, Hkv, Sk, Dh = 32, 8, 65536, 128
        assert Hq % Hkv == 0, (Hq, Hkv)
        return {
            "x": _w((lambda *s: torch.randn(*s, dtype=torch.bfloat16) * 0.05)(B, Sq, D)),
            "k_cache": _w((lambda *s: torch.randn(*s, dtype=torch.bfloat16) * 0.8)(B, Hkv, Sk, Dh)),
            "v_cache": _w((lambda *s: torch.randn(*s, dtype=torch.bfloat16) * 1.6)(B, Hkv, Sk, Dh)),
            "wq": _w((lambda *s: torch.randn(*s, dtype=torch.bfloat16) * 0.8)(D, Hq * Dh) * (D ** -0.5)),
            "wo": _w((lambda *s: torch.randn(*s, dtype=torch.bfloat16) * 1.6)(Hq * Dh, D) * ((Hq * Dh) ** -0.5)),
        }
    _A_in = _A_setup()

    def _B_setup():
        B, S, D, F = 1, 1, 512, 1792
        return {
            "x": _w((lambda *s: torch.randn(*s, dtype=torch.bfloat16) * 0.05)(B, S, D)),
            "w1": _w((lambda *s: torch.randn(*s, dtype=torch.bfloat16) * 1.6)(D, F) * (D ** -0.5)),
            "b1": _w((lambda *s: torch.randn(*s, dtype=torch.bfloat16) * 1.6)(F) * 0.01),
            "w2": _w((lambda *s: torch.randn(*s, dtype=torch.bfloat16) * 0.2)(F, D) * (F ** -0.5)),
            "b2": _w((lambda *s: torch.randn(*s, dtype=torch.bfloat16) * 0.2)(D) * 0.01),
        }
    _B_in = _B_setup()

    return {
        "A_x": _A_in["x"],
        "A_k_cache": _A_in["k_cache"],
        "A_v_cache": _A_in["v_cache"],
        "A_wq": _A_in["wq"],
        "A_wo": _A_in["wo"],
        "B_x": _B_in["x"],
        "B_w1": _B_in["w1"],
        "B_b1": _B_in["b1"],
        "B_w2": _B_in["w2"],
        "B_b2": _B_in["b2"],
    }

def reference(A_x, A_k_cache, A_v_cache, A_wq, A_wo, B_x, B_w1, B_b1, B_w2, B_b2):
    def _A_ref(x, k_cache, v_cache, wq, wo):
        B, Sq, D = x.shape
        Hq, Dh = 32, 128
        Hkv, Sk = k_cache.shape[1], k_cache.shape[2]
        W = min(4096, max(256, Sk // 4))
        rep = Hq // Hkv
        q = (lambda x, *d: x.permute(*d))((x @ wq).reshape(B, Sq, Hq, Dh), 0, 2, 1, 3)
        k = (lambda x, n, axis: torch.repeat_interleave(x, n, dim=axis))(k_cache[:, :, Sk - W:, :], rep, axis=1)
        v = (lambda x, n, axis: torch.repeat_interleave(x, n, dim=axis))(v_cache[:, :, Sk - W:, :], rep, axis=1)
        scores = torch.einsum("bhqd,bhkd->bhqk", q, k) * (Dh ** -0.5)
        p = _softmax(scores, axis=-1)
        o = torch.einsum("bhqk,bhkd->bhqd", p, v)
        return (lambda x, *d: x.permute(*d))(o, 0, 2, 1, 3).reshape(B, Sq, Hq * Dh) @ wo

    def _B_ref(x, w1, b1, w2, b2):
        h = torch.einsum("bsd,df->bsf", x, w1) + b1
        h = _gelu(h)
        return torch.einsum("bsf,fd->bsd", h, w2) + b2

    x = A_x
    x = x + _A_ref(_layernorm(x, axis=-1), A_k_cache, A_v_cache, A_wq, A_wo)
    x = x + _B_ref(_layernorm(x, axis=-1), B_w1, B_b1, B_w2, B_b2)
    x = x + _A_ref(_layernorm(x, axis=-1), A_k_cache, A_v_cache, A_wq, A_wo)
    x = x + _B_ref(_layernorm(x, axis=-1), B_w1, B_b1, B_w2, B_b2)
    return x
```

```asm
; @launch grid=(632,1,1) block=(256,1,1) lds=20480
.amdgcn_target "amdgcn-amd-amdhsa--gfx950"
.text
.globl interleave_layers__sliding_block_cached__dense_activation_gelu__decode_kernel
.p2align 8
.type interleave_layers__sliding_block_cached__dense_activation_gelu__decode_kernel,@function
interleave_layers__sliding_block_cached__dense_activation_gelu__decode_kernel:
    s_cmp_ge_u32 s2, 632
    s_cbranch_scc1 L_end
    s_load_dwordx16 s[4:19], s[0:1], 0
    s_load_dwordx8 s[20:27], s[0:1], 64
    s_load_dwordx2 s[28:29], s[0:1], 96
    v_and_b32 v1, 63, v0
    v_lshrrev_b32 v2, 4, v1
    v_and_b32 v3, 15, v0
    v_lshrrev_b32 v4, 6, v0
    s_nop 0
    v_readfirstlane_b32 s33, v4
    s_and_b32 s31, s2, 7
    s_mov_b32 s60, 0x05040100
    s_mov_b32 s61, 0x07060302
    s_mov_b32 s80, 0x3fb8aa3b
    s_mov_b32 s81, 0x3db504f3
    s_mov_b32 s30, 0
    s_mov_b32 s84, 0
    s_mov_b32 s82, 0xaaaaaaaa
    s_mov_b32 s83, 0xaaaaaaaa
    s_mov_b32 s77, 0x0
    s_mov_b32 s78, 400000
    s_waitcnt lgkmcnt(0)
    s_mov_b32 s36, s28
    s_and_b32 s37, s29, 0xffff
    s_mov_b32 s38, 0x20000000
    s_mov_b32 s39, 0x00020000
    s_mov_b32 s52, s26
    s_and_b32 s53, s27, 0xffff
    s_mov_b32 s54, 0x100
    s_mov_b32 s55, 0x00020000
    s_or_b32 s35, s2, s33
    s_cmp_lg_u32 s35, 0
    s_cbranch_scc1 Lnn_1
    s_memrealtime s[62:63]
    s_waitcnt lgkmcnt(0)
    s_or_b32 s62, s62, 1
    v_mov_b32 v5, s62
    buffer_store_dword v5, off, s[52:55], 0 sc1
    s_nop 0
Lnn_1:
    s_cmp_ge_u32 s2, 376
    s_cbranch_scc1 L_wo
    s_cmp_ge_u32 s2, 320
    s_cbranch_scc1 L_ffn
    s_cmp_ge_u32 s2, 64
    s_cbranch_scc1 L_att
    s_branch L_wq
L_wq:
    s_sub_u32 s32, s2, 0
    s_lshr_b32 s32, s32, 3
    s_mov_b32 s40, s10
    s_and_b32 s41, s11, 0xffff
    s_mov_b32 s42, 0x400000
    s_mov_b32 s43, 0x00020000
    s_mov_b32 s44, s4
    s_and_b32 s45, s5, 0xffff
    s_mov_b32 s46, 0x400
    s_mov_b32 s47, 0x00020000
    s_mov_b32 s48, s22
    s_and_b32 s49, s23, 0xffff
    s_mov_b32 s50, 0x400
    s_mov_b32 s51, 0x00020000
    s_mov_b32 s64, s24
    s_and_b32 s65, s25, 0xffff
    s_mov_b32 s66, 0x400
    s_mov_b32 s67, 0x00020000
    v_lshlrev_b32 v5, 2, v0
    v_lshlrev_b32 v6, 3, v0
    v_and_b32 v4, 1, v1
    v_lshlrev_b32 v4, 13, v4
    v_lshrrev_b32 v7, 1, v0
    v_lshl_add_u32 v7, v7, 4, v4
    s_mov_b32 s3, 0x03020107
    s_mov_b32 s62, 0x03020106
    s_mov_b32 s63, 0x03020105
    s_mov_b32 s72, 0x00040c0c
    s_mov_b32 s73, 0x0302040c
    buffer_load_dword v14, v5, s[44:47], 0 offen
    buffer_load_dword v15, v5, s[48:51], 0 offen
    v_lshlrev_b32 v8, 16, v2
    v_lshl_add_u32 v8, v3, 3, v8
    s_lshl_b32 s56, s33, 20
    s_lshl_b32 s35, s31, 10
    s_add_u32 s56, s56, s35
    s_lshl_b32 s35, s32, 7
    s_add_u32 s56, s56, s35
    s_add_u32 s35, s56, 0x0
    buffer_load_dwordx2 v[48:49], v8, s[40:43], s35 offen nt
    s_add_u32 s35, s56, 0x2000
    buffer_load_dwordx2 v[50:51], v8, s[40:43], s35 offen nt
    s_add_u32 s35, s56, 0x4000
    buffer_load_dwordx2 v[52:53], v8, s[40:43], s35 offen nt
    s_add_u32 s35, s56, 0x6000
    buffer_load_dwordx2 v[54:55], v8, s[40:43], s35 offen nt
    s_add_u32 s35, s56, 0x8000
    buffer_load_dwordx2 v[56:57], v8, s[40:43], s35 offen nt
    s_add_u32 s35, s56, 0xa000
    buffer_load_dwordx2 v[58:59], v8, s[40:43], s35 offen nt
    s_add_u32 s35, s56, 0xc000
    buffer_load_dwordx2 v[60:61], v8, s[40:43], s35 offen nt
    s_add_u32 s35, s56, 0xe000
    buffer_load_dwordx2 v[62:63], v8, s[40:43], s35 offen nt
    s_add_u32 s35, s56, 0x40000
    buffer_load_dwordx2 v[64:65], v8, s[40:43], s35 offen nt
    s_add_u32 s35, s56, 0x42000
    buffer_load_dwordx2 v[66:67], v8, s[40:43], s35 offen nt
    s_add_u32 s35, s56, 0x44000
    buffer_load_dwordx2 v[68:69], v8, s[40:43], s35 offen nt
    s_add_u32 s35, s56, 0x46000
    buffer_load_dwordx2 v[70:71], v8, s[40:43], s35 offen nt
    s_add_u32 s35, s56, 0x48000
    buffer_load_dwordx2 v[72:73], v8, s[40:43], s35 offen nt
    s_add_u32 s35, s56, 0x4a000
    buffer_load_dwordx2 v[74:75], v8, s[40:43], s35 offen nt
    s_add_u32 s35, s56, 0x4c000
    buffer_load_dwordx2 v[76:77], v8, s[40:43], s35 offen nt
    s_add_u32 s35, s56, 0x4e000
    buffer_load_dwordx2 v[78:79], v8, s[40:43], s35 offen nt
    s_add_u32 s35, s56, 0x80000
    buffer_load_dwordx2 v[80:81], v8, s[40:43], s35 offen nt
    s_add_u32 s35, s56, 0x82000
    buffer_load_dwordx2 v[82:83], v8, s[40:43], s35 offen nt
    s_add_u32 s35, s56, 0x84000
    buffer_load_dwordx2 v[84:85], v8, s[40:43], s35 offen nt
    s_add_u32 s35, s56, 0x86000
    buffer_load_dwordx2 v[86:87], v8, s[40:43], s35 offen nt
    s_add_u32 s35, s56, 0x88000
    buffer_load_dwordx2 v[88:89], v8, s[40:43], s35 offen nt
    s_add_u32 s35, s56, 0x8a000
    buffer_load_dwordx2 v[90:91], v8, s[40:43], s35 offen nt
    s_add_u32 s35, s56, 0x8c000
    buffer_load_dwordx2 v[92:93], v8, s[40:43], s35 offen nt
    s_add_u32 s35, s56, 0x8e000
    buffer_load_dwordx2 v[94:95], v8, s[40:43], s35 offen nt
    s_add_u32 s35, s56, 0xc0000
    buffer_load_dwordx2 v[128:129], v8, s[40:43], s35 offen nt
    s_add_u32 s35, s56, 0xc2000
    buffer_load_dwordx2 v[130:131], v8, s[40:43], s35 offen nt
    s_add_u32 s35, s56, 0xc4000
    buffer_load_dwordx2 v[132:133], v8, s[40:43], s35 offen nt
    s_add_u32 s35, s56, 0xc6000
    buffer_load_dwordx2 v[134:135], v8, s[40:43], s35 offen nt
    s_add_u32 s35, s56, 0xc8000
    buffer_load_dwordx2 v[136:137], v8, s[40:43], s35 offen nt
    s_add_u32 s35, s56, 0xca000
    buffer_load_dwordx2 v[138:139], v8, s[40:43], s35 offen nt
    s_add_u32 s35, s56, 0xcc000
    buffer_load_dwordx2 v[140:141], v8, s[40:43], s35 offen nt
    s_add_u32 s35, s56, 0xce000
    buffer_load_dwordx2 v[142:143], v8, s[40:43], s35 offen nt
    s_lshl_b32 s35, s33, 8
    s_add_u32 s35, s35, 64
    v_lshlrev_b32 v9, 2, v1
    v_add_u32 v9, s35, v9
    v_lshlrev_b32 v10, 4, v2
    v_add_u32 v10, s35, v10
    s_lshl_b32 s35, s33, 3
    v_mov_b32 v11, s35
    s_lshl_b32 s35, s33, 8
    s_add_u32 s35, s35, 2048
    v_lshlrev_b32 v12, 4, v3
    v_add_u32 v12, s35, v12
    v_add_u32 v13, 2048, v6
    s_lshl_b32 s69, s32, 8
    s_nop 0
L_wq_init:
    s_mov_b32 s77, 0x0
    s_mov_b32 s78, 400000
    s_mov_b32 s79, 1
    v_mov_b32 v18, 12288
    s_cmp_lg_u32 s33, 0
    s_nop 0
    s_cbranch_scc1 Lns_2
    s_mov_b32 s34, 0
Ln_3:
    buffer_load_dword v16, off, s[52:55], 0 sc1
    s_waitcnt vmcnt(0)
    v_readfirstlane_b32 s30, v16
    s_cmp_lg_u32 s30, 0
    s_nop 3
    s_cbranch_scc1 Lnd_4
    s_sleep 2
    s_add_u32 s34, s34, 1
    s_cmp_lt_u32 s34, 400000
    s_cbranch_scc1 Ln_3
Lnd_4:
    v_mov_b32 v16, s30
    ds_write_b32 v18, v16
    s_waitcnt lgkmcnt(0)
Lns_2:
    s_barrier
    ds_read_b32 v16, v18
    s_waitcnt lgkmcnt(0)
    v_readfirstlane_b32 s30, v16
    s_waitcnt vmcnt(0)
    s_cmp_lg_u32 s33, 0
    s_nop 2
    s_cbranch_scc1 Lcp_5
    s_getreg_b32 s35, hwreg(HW_REG_XCC_ID)
    v_mov_b32 v16, s35
    v_mov_b32 v17, s30
    s_lshl_b32 s56, s31, 10
    s_lshl_b32 s35, s32, 3
    s_add_u32 s56, s56, s35
    s_add_u32 s56, s56, 0x60000
    s_mov_b64 exec, 1
    buffer_store_dwordx2 v[16:17], off, s[36:39], s56 sc1
    s_mov_b64 exec, -1
Lcp_5:
    v_perm_b32 v32, v50, v48, s60
    v_perm_b32 v36, v50, v48, s61
    v_perm_b32 v40, v51, v49, s60
    v_perm_b32 v44, v51, v49, s61
    v_perm_b32 v33, v54, v52, s60
    v_perm_b32 v37, v54, v52, s61
    v_perm_b32 v41, v55, v53, s60
    v_perm_b32 v45, v55, v53, s61
    v_perm_b32 v34, v58, v56, s60
    v_perm_b32 v38, v58, v56, s61
    v_perm_b32 v42, v59, v57, s60
    v_perm_b32 v46, v59, v57, s61
    v_perm_b32 v35, v62, v60, s60
    v_perm_b32 v39, v62, v60, s61
    v_perm_b32 v43, v63, v61, s60
    v_perm_b32 v47, v63, v61, s61
    v_perm_b32 v48, v66, v64, s60
    v_perm_b32 v52, v66, v64, s61
    v_perm_b32 v56, v67, v65, s60
    v_perm_b32 v60, v67, v65, s61
    v_perm_b32 v49, v70, v68, s60
    v_perm_b32 v53, v70, v68, s61
    v_perm_b32 v57, v71, v69, s60
    v_perm_b32 v61, v71, v69, s61
    v_perm_b32 v50, v74, v72, s60
    v_perm_b32 v54, v74, v72, s61
    v_perm_b32 v58, v75, v73, s60
    v_perm_b32 v62, v75, v73, s61
    v_perm_b32 v51, v78, v76, s60
    v_perm_b32 v55, v78, v76, s61
    v_perm_b32 v59, v79, v77, s60
    v_perm_b32 v63, v79, v77, s61
    v_perm_b32 v64, v82, v80, s60
    v_perm_b32 v68, v82, v80, s61
    v_perm_b32 v72, v83, v81, s60
    v_perm_b32 v76, v83, v81, s61
    v_perm_b32 v65, v86, v84, s60
    v_perm_b32 v69, v86, v84, s61
    v_perm_b32 v73, v87, v85, s60
    v_perm_b32 v77, v87, v85, s61
    v_perm_b32 v66, v90, v88, s60
    v_perm_b32 v70, v90, v88, s61
    v_perm_b32 v74, v91, v89, s60
    v_perm_b32 v78, v91, v89, s61
    v_perm_b32 v67, v94, v92, s60
    v_perm_b32 v71, v94, v92, s61
    v_perm_b32 v75, v95, v93, s60
    v_perm_b32 v79, v95, v93, s61
    v_perm_b32 v80, v130, v128, s60
    v_perm_b32 v84, v130, v128, s61
    v_perm_b32 v88, v131, v129, s60
    v_perm_b32 v92, v131, v129, s61
    v_perm_b32 v81, v134, v132, s60
    v_perm_b32 v85, v134, v132, s61
    v_perm_b32 v89, v135, v133, s60
    v_perm_b32 v93, v135, v133, s61
    v_perm_b32 v82, v138, v136, s60
    v_perm_b32 v86, v138, v136, s61
    v_perm_b32 v90, v139, v137, s60
    v_perm_b32 v94, v139, v137, s61
    v_perm_b32 v83, v142, v140, s60
    v_perm_b32 v87, v142, v140, s61
    v_perm_b32 v91, v143, v141, s60
    v_perm_b32 v95, v143, v141, s61
    v_lshlrev_b32 v28, 16, v15
    v_and_b32 v29, 0xffff0000, v15
    v_lshlrev_b32 v26, 16, v14
    v_and_b32 v27, 0xffff0000, v14
    v_mov_b32 v18, v14
    s_mov_b32 s35, 0x3f803f80
    v_mov_b32 v96, s35
    v_mov_b32 v97, s35
    v_mov_b32 v98, s35
    v_mov_b32 v99, s35
    v_mov_b32 v100, s35
    v_mov_b32 v101, s35
    v_mov_b32 v102, s35
    v_mov_b32 v103, s35
    v_mov_b32 v104, s35
    v_mov_b32 v105, s35
    v_mov_b32 v106, s35
    v_mov_b32 v107, s35
    v_mov_b32 v108, s35
    v_mov_b32 v109, s35
    v_mov_b32 v110, s35
    v_mov_b32 v111, s35
    v_mfma_f32_16x16x32_bf16 v[112:115], v[96:99], v[32:35], 0
    v_mfma_f32_16x16x32_bf16 v[116:119], v[96:99], v[36:39], 0
    v_mfma_f32_16x16x32_bf16 v[120:123], v[96:99], v[40:43], 0
    v_mfma_f32_16x16x32_bf16 v[124:127], v[96:99], v[44:47], 0
    v_mfma_f32_16x16x32_bf16 v[112:115], v[100:103], v[48:51], v[112:115]
    v_mfma_f32_16x16x32_bf16 v[116:119], v[100:103], v[52:55], v[116:119]
    v_mfma_f32_16x16x32_bf16 v[120:123], v[100:103], v[56:59], v[120:123]
    v_mfma_f32_16x16x32_bf16 v[124:127], v[100:103], v[60:63], v[124:127]
    v_mfma_f32_16x16x32_bf16 v[112:115], v[104:107], v[64:67], v[112:115]
    v_mfma_f32_16x16x32_bf16 v[116:119], v[104:107], v[68:71], v[116:119]
    v_mfma_f32_16x16x32_bf16 v[120:123], v[104:107], v[72:75], v[120:123]
    v_mfma_f32_16x16x32_bf16 v[124:127], v[104:107], v[76:79], v[124:127]
    v_mfma_f32_16x16x32_bf16 v[112:115], v[108:111], v[80:83], v[112:115]
    v_mfma_f32_16x16x32_bf16 v[116:119], v[108:111], v[84:87], v[116:119]
    v_mfma_f32_16x16x32_bf16 v[120:123], v[108:111], v[88:91], v[120:123]
    v_mfma_f32_16x16x32_bf16 v[124:127], v[108:111], v[92:95], v[124:127]
    s_nop 4
    ds_write_b32 v12, v112 offset:0
    ds_write_b32 v12, v116 offset:4
    ds_write_b32 v12, v120 offset:8
    ds_write_b32 v12, v124 offset:12
    s_waitcnt lgkmcnt(0)
    s_barrier
    ds_read_b64 v[16:17], v13 offset:0
    ds_read_b64 v[18:19], v13 offset:256
    ds_read_b64 v[20:21], v13 offset:512
    ds_read_b64 v[22:23], v13 offset:768
    s_waitcnt lgkmcnt(0)
    v_add_f32 v16, v16, v18
    v_add_f32 v17, v17, v19
    v_add_f32 v20, v20, v22
    v_add_f32 v21, v21, v23
    v_add_f32 v16, v16, v20
    v_add_f32 v17, v17, v21
    v_mov_b32 v128, v16
    v_mov_b32 v129, v17
    s_nop 1
    s_barrier
    v_mov_b32 v18, v14
    s_nop 1
L_wqA:
    s_or_b32 s35, s32, s33
    s_cmp_lg_u32 s35, 0
    s_cbranch_scc1 Lan_6
    v_mov_b32 v24, s30
    v_mov_b32 v25, s30
    s_lshl_b32 s56, s31, 7
    s_add_u32 s56, s56, s77
    s_add_u32 s56, s56, 0x50000
    s_mov_b64 exec, 1
    buffer_store_dwordx2 v[24:25], v6, s[36:39], s56 offen
    s_add_u32 s59, s56, 0x4000000
    buffer_store_dwordx2 v[24:25], v6, s[36:39], s59 offen sc1
    s_mov_b64 exec, -1
Lan_6:
    s_cmp_lg_u32 s2, 0
    s_cbranch_scc1 Lxb_7
    v_mov_b32 v30, v18
    v_mov_b32 v31, s30
    s_add_u32 s56, s77, 0x41000
    buffer_store_dwordx2 v[30:31], v6, s[36:39], s56 offen sc1
Lxb_7:
    ds_write_b32 v9, v18
    v_add_f32 v20, v26, v27
    v_mul_f32 v21, v26, v26
    v_fmac_f32 v21, v27, v27
    s_waitcnt lgkmcnt(0)
    ds_read_b128 v[96:99], v10 offset:0
    ds_read_b128 v[100:103], v10 offset:64
    ds_read_b128 v[104:107], v10 offset:128
    ds_read_b128 v[108:111], v10 offset:192
    v_add_f32_dpp v20, v20, v20 row_ror:8 row_mask:0xf bank_mask:0xf
    v_add_f32_dpp v21, v21, v21 row_ror:8 row_mask:0xf bank_mask:0xf
    s_nop 0
    v_add_f32_dpp v20, v20, v20 row_ror:4 row_mask:0xf bank_mask:0xf
    v_add_f32_dpp v21, v21, v21 row_ror:4 row_mask:0xf bank_mask:0xf
    s_nop 0
    v_add_f32_dpp v20, v20, v20 row_ror:2 row_mask:0xf bank_mask:0xf
    v_add_f32_dpp v21, v21, v21 row_ror:2 row_mask:0xf bank_mask:0xf
    s_nop 0
    v_add_f32_dpp v20, v20, v20 row_ror:1 row_mask:0xf bank_mask:0xf
    v_add_f32_dpp v21, v21, v21 row_ror:1 row_mask:0xf bank_mask:0xf
    v_mov_b32 v22, v20
    v_mov_b32 v23, v21
    s_nop 0
    v_permlane16_swap_b32 v20, v22
    v_permlane16_swap_b32 v21, v23
    v_add_f32 v20, v20, v22
    v_add_f32 v21, v21, v23
    v_mov_b32 v22, v20
    v_mov_b32 v23, v21
    s_nop 0
    v_permlane32_swap_b32 v20, v22
    v_permlane32_swap_b32 v21, v23
    v_add_f32 v20, v20, v22
    v_add_f32 v21, v21, v23
    s_waitcnt lgkmcnt(0)
    v_mfma_f32_16x16x32_bf16 v[112:115], v[96:99], v[32:35], 0
    v_mfma_f32_16x16x32_bf16 v[116:119], v[96:99], v[36:39], 0
    v_mfma_f32_16x16x32_bf16 v[120:123], v[96:99], v[40:43], 0
    v_mfma_f32_16x16x32_bf16 v[124:127], v[96:99], v[44:47], 0
    v_mfma_f32_16x16x32_bf16 v[112:115], v[100:103], v[48:51], v[112:115]
    v_mfma_f32_16x16x32_bf16 v[116:119], v[100:103], v[52:55], v[116:119]
    v_mfma_f32_16x16x32_bf16 v[120:123], v[100:103], v[56:59], v[120:123]
    v_mfma_f32_16x16x32_bf16 v[124:127], v[100:103], v[60:63], v[124:127]
    v_mfma_f32_16x16x32_bf16 v[112:115], v[104:107], v[64:67], v[112:115]
    v_mfma_f32_16x16x32_bf16 v[116:119], v[104:107], v[68:71], v[116:119]
    v_mfma_f32_16x16x32_bf16 v[120:123], v[104:107], v[72:75], v[120:123]
    v_mfma_f32_16x16x32_bf16 v[124:127], v[104:107], v[76:79], v[124:127]
    v_mfma_f32_16x16x32_bf16 v[112:115], v[108:111], v[80:83], v[112:115]
    v_mfma_f32_16x16x32_bf16 v[116:119], v[108:111], v[84:87], v[116:119]
    v_mfma_f32_16x16x32_bf16 v[120:123], v[108:111], v[88:91], v[120:123]
    v_mfma_f32_16x16x32_bf16 v[124:127], v[108:111], v[92:95], v[124:127]
    s_nop 4
    ds_write_b32 v12, v112 offset:0
    ds_write_b32 v12, v116 offset:4
    ds_write_b32 v12, v120 offset:8
    ds_write_b32 v12, v124 offset:12
    ds_write_b64 v11, v[20:21]
    s_lshl_b32 s56, s31, 11
    s_add_u32 s56, s56, s77
    s_add_u32 s56, s56, s69
    v_mov_b32 v25, 0
    s_waitcnt lgkmcnt(0)
    s_nop 0
    s_barrier
    s_cmp_lg_u32 s33, 0
    s_cbranch_scc1 Lq_8
    s_mov_b32 exec_hi, 0
    ds_read_b128 v[96:99], v25 offset:0
    ds_read_b128 v[100:103], v25 offset:16
    ds_read_b64 v[16:17], v13 offset:0
    ds_read_b64 v[18:19], v13 offset:256
    ds_read_b64 v[20:21], v13 offset:512
    ds_read_b64 v[22:23], v13 offset:768
    s_waitcnt lgkmcnt(0)
    v_add_f32 v16, v16, v18
    v_add_f32 v17, v17, v19
    v_add_f32 v20, v20, v22
    v_add_f32 v21, v21, v23
    v_add_f32 v16, v16, v20
    v_add_f32 v17, v17, v21
    v_add_f32 v96, v96, v98
    v_add_f32 v97, v97, v99
    v_add_f32 v100, v100, v102
    v_add_f32 v101, v101, v103
    v_add_f32 v96, v96, v100
    v_add_f32 v97, v97, v101
    v_mul_f32 v96, 0x3b000000, v96
    v_mul_f32 v97, 0x3b000000, v97
    v_fma_f32 v97, -v96, v96, v97
    v_max_f32 v97, 0, v97
    v_cvt_pk_bf16_f32 v98, v96, v97
    v_lshlrev_b32 v96, 16, v98
    v_and_b32 v97, 0xffff0000, v98
    v_add_f32 v97, 0x3727c5ac, v97
    v_cvt_pk_bf16_f32 v97, v97, v97
    v_lshlrev_b32 v97, 16, v97
    v_sqrt_f32 v97, v97
    s_nop 0
    v_cvt_pk_bf16_f32 v97, v97, v97
    v_lshlrev_b32 v97, 16, v97
    v_rcp_f32 v97, v97
    v_fma_f32 v16, -v96, v128, v16
    v_fma_f32 v17, -v96, v129, v17
    v_mul_f32 v16, v16, v97
    v_mul_f32 v17, v17, v97
    v_cvt_pk_bf16_f32 v16, v16, v17
    v_mov_b32 v17, s30
    buffer_store_dwordx2 v[16:17], v6, s[36:39], s56 offen
    s_add_u32 s59, s56, 0x4000000
    buffer_store_dwordx2 v[16:17], v6, s[36:39], s59 offen sc1
    s_mov_b64 exec, -1
Lq_8:
    s_cmp_eq_u32 s79, 0
    s_cbranch_scc1 L_wq_init
    s_cmp_eq_u32 s79, 4
    s_cbranch_scc1 Lst4_9
    s_mov_b32 s84, 0
    v_mov_b32 v22, 12292
    s_cmp_lg_u32 s33, 0
    s_nop 0
    s_cbranch_scc1 Lcw_10
    s_lshl_b32 s56, s31, 10
    s_add_u32 s56, s56, 0x60000
    v_lshlrev_b32 v20, 3, v1
    v_min_u32 v21, 14, v1
    v_lshlrev_b32 v21, 3, v21
    s_mov_b32 s34, 0
    s_nop 0
Lcwp_11:
    buffer_load_dwordx2 v[16:17], v20, s[36:39], s56 offen sc1
    buffer_load_dwordx2 v[18:19], v21, s[36:39], s56 offen offset:512 sc1
    s_waitcnt vmcnt(0)
    v_cmp_ne_u32 vcc, s30, v17
    v_cmp_ne_u32 s[70:71], s30, v19
    s_or_b64 vcc, vcc, s[70:71]
    s_nop 3
    s_cbranch_vccz Lcwd_12
    s_sleep 4
    s_add_u32 s34, s34, 1
    s_cmp_lt_u32 s34, 400000
    s_cbranch_scc1 Lcwp_11
Lcwd_12:
    s_getreg_b32 s35, hwreg(HW_REG_XCC_ID)
    v_cmp_ne_u32 vcc, s35, v16
    v_cmp_ne_u32 s[70:71], s35, v18
    s_or_b64 vcc, vcc, s[70:71]
    s_cmp_eq_u64 vcc, 0
    s_cselect_b32 s35, 1, 0
    s_cmp_lt_u32 s34, 400000
    s_cselect_b32 s35, s35, 0
    v_mov_b32 v16, s35
    ds_write_b32 v22, v16
    s_waitcnt lgkmcnt(0)
Lcw_10:
    s_barrier
    ds_read_b32 v16, v22
    s_waitcnt lgkmcnt(0)
    v_readfirstlane_b32 s84, v16
    s_mov_b32 s79, 3
    s_nop 3
    s_branch L_wqB
Lst4_9:
    s_cmp_lg_u32 s2, 0
    s_cbranch_scc1 L_end
    s_mov_b32 s79, 5
L_wqB:
    s_lshl_b32 s57, s31, 7
    s_add_u32 s57, s57, s77
    s_add_u32 s57, s57, 0x53000
    s_cmp_lg_u32 s33, 0
    s_cbranch_scc1 Lgs_13
    s_mov_b32 s34, 0
    s_add_u32 s58, s57, 0x4000000
    s_cmp_lg_u32 s84, 0
    s_cselect_b32 s58, s57, s58
Lgp_14:
    s_and_b32 s35, s34, 15
    s_cmp_eq_u32 s35, 15
    s_cselect_b32 s56, s58, s57
    buffer_load_dword v16, off, s[36:39], s56 offset:4 sc1
    s_waitcnt vmcnt(0)
    v_readfirstlane_b32 s35, v16
    s_cmp_eq_u32 s35, s30
    s_nop 3
    s_cbranch_scc1 Lgs_13
    s_sleep 1
    s_add_u32 s34, s34, 1
    s_cmp_lt_u32 s34, s78
    s_cbranch_scc1 Lgp_14
Lgs_13:
    s_barrier
    s_and_b32 s74, s31, 7
    s_lshl_b32 s74, s74, 14
    s_add_u32 s74, s74, s77
    s_add_u32 s75, s74, 0xe1000
    s_add_u32 s74, s74, 0xe0000
    s_add_u32 s76, s77, 0x40000
    s_mov_b32 s34, 0
Lp_15:
    buffer_load_dwordx4 v[96:99], v7, s[36:39], s74 offen offset:0 sc1
    buffer_load_dwordx4 v[100:103], v7, s[36:39], s74 offen offset:2048 sc1
    buffer_load_dwordx4 v[104:107], v7, s[36:39], s75 offen offset:0 sc1
    buffer_load_dwordx4 v[108:111], v7, s[36:39], s75 offen offset:2048 sc1
    buffer_load_dwordx2 v[30:31], v6, s[36:39], s76 offen sc1
    s_waitcnt vmcnt(0)
    v_min3_u32 v16, v99, v103, v107
    v_max3_u32 v17, v99, v103, v107
    v_min3_u32 v16, v16, v111, v31
    v_max3_u32 v17, v17, v111, v31
    v_cmp_ne_u32 vcc, s30, v16
    v_cmp_ne_u32 s[70:71], s30, v17
    s_or_b64 vcc, vcc, s[70:71]
    s_nop 3
    s_cbranch_vccz Ld_16
    s_add_u32 s34, s34, 1
    s_cmp_lt_u32 s34, s78
    s_cbranch_scc1 Lp_15
Ld_16:
    v_perm_b32 v20, v97, v96, s72
    v_perm_b32 v21, v101, v100, s72
    v_perm_b32 v22, v105, v104, s72
    v_perm_b32 v23, v109, v108, s72
    v_perm_b32 v99, v98, v20, s73
    v_perm_b32 v103, v102, v21, s73
    v_perm_b32 v107, v106, v22, s73
    v_perm_b32 v111, v110, v23, s73
    v_add_f32 v96, v96, v100
    v_add_f32 v97, v97, v101
    v_add_f32 v98, v98, v102
    v_add_f32 v99, v99, v103
    v_add_f32 v104, v104, v108
    v_add_f32 v105, v105, v109
    v_add_f32 v106, v106, v110
    v_add_f32 v107, v107, v111
    v_add_f32 v96, v96, v104
    v_add_f32 v97, v97, v105
    v_add_f32 v98, v98, v106
    v_add_f32 v99, v99, v107
    v_cndmask_b32 v20, v98, v96, s[82:83]
    v_cndmask_b32 v21, v99, v97, s[82:83]
    v_cndmask_b32 v26, v96, v98, s[82:83]
    v_cndmask_b32 v27, v97, v99, s[82:83]
    s_nop 0
    v_add_f32_dpp v26, v20, v26 quad_perm:[1,0,3,2] row_mask:0xf bank_mask:0xf
    v_add_f32_dpp v27, v21, v27 quad_perm:[1,0,3,2] row_mask:0xf bank_mask:0xf
    v_cvt_pk_bf16_f32 v18, v26, v27
    v_lshlrev_b32 v26, 16, v18
    v_and_b32 v27, 0xffff0000, v18
    v_add_f32 v26, v26, v28
    v_add_f32 v27, v27, v29
    v_cvt_pk_bf16_f32 v18, v26, v27
    v_lshlrev_b32 v26, 16, v18
    v_and_b32 v27, 0xffff0000, v18
    v_lshlrev_b32 v19, 16, v30
    v_and_b32 v20, 0xffff0000, v30
    v_add_f32 v26, v26, v19
    v_add_f32 v27, v27, v20
    v_cvt_pk_bf16_f32 v18, v26, v27
    v_lshlrev_b32 v26, 16, v18
    v_and_b32 v27, 0xffff0000, v18
    s_cmp_eq_u32 s79, 3
    s_nop 0
    s_cbranch_scc1 Lst3_17
    s_cmp_eq_u32 s79, 5
    s_cbranch_scc1 Lst5_18
    s_mov_b32 s79, 3
    s_mov_b32 s77, 0x0
    s_mov_b32 s78, 400000
    s_branch L_wqB
Lst3_17:
    s_mov_b32 s79, 4
    s_add_u32 s30, s30, 1
    s_branch L_wqA
Lst5_18:
    buffer_store_dword v18, v5, s[64:67], 0 offen
    s_branch L_end
L_att:
    s_sub_u32 s32, s2, 64
    s_lshr_b32 s32, s32, 3
    s_mov_b32 s40, s6
    s_and_b32 s41, s7, 0xffff
    s_mov_b32 s42, 0x8000000
    s_mov_b32 s43, 0x00020000
    s_mov_b32 s44, s8
    s_and_b32 s45, s9, 0xffff
    s_mov_b32 s46, 0x8000000
    s_mov_b32 s47, 0x00020000
    v_lshlrev_b32 v128, 8, v3
    v_lshl_add_u32 v128, v2, 4, v128
    v_lshlrev_b32 v129, 10, v2
    v_lshl_add_u32 v129, v3, 4, v129
    s_lshl_b32 s56, s31, 24
    s_lshl_b32 s35, s32, 15
    s_add_u32 s56, s56, s35
    s_lshl_b32 s35, s33, 13
    s_add_u32 s56, s56, s35
    s_add_u32 s68, s56, 0xf00000
    v_lshrrev_b32 v4, 2, v3
    v_add_u32 v4, v4, v3
    v_and_b32 v4, 3, v4
    v_lshlrev_b32 v130, 4, v1
    s_lshl_b32 s35, s33, 10
    s_add_u32 s35, s35, 12544
    v_lshlrev_b32 v139, 3, v1
    v_add_u32 v139, s35, v139
    v_lshlrev_b32 v140, 8, v4
    v_lshl_add_u32 v140, v2, 4, v140
    v_add_u32 v140, s35, v140
    v_lshrrev_b32 v4, 1, v3
    s_lshl_b32 s35, s33, 3
    v_add_u32 v4, s35, v4
    v_lshlrev_b32 v4, 13, v4
    v_and_b32 v5, 1, v3
    v_lshl_add_u32 v5, v5, 2, v2
    v_lshl_add_u32 v131, v5, 4, v4
    s_lshl_b32 s35, s32, 7
    v_add_u32 v131, s35, v131
    s_lshl_b32 s35, s32, 4
    s_add_u32 s35, s35, 4096
    v_add_u32 v142, s35, v4
    v_lshlrev_b32 v132, 4, v1
    v_and_b32 v4, 31, v1
    v_lshlrev_b32 v4, 4, v4
    v_add_u32 v133, 4096, v4
    v_lshrrev_b32 v4, 3, v1
    v_lshlrev_b32 v4, 4, v4
    v_add_u32 v143, 4096, v4
    s_lshl_b32 s35, s32, 6
    v_lshlrev_b32 v134, 3, v1
    v_add_u32 v134, s35, v134
    s_mul_i32 s35, s33, 2304
    v_lshlrev_b32 v135, 2, v1
    v_add_u32 v135, s35, v135
    s_lshl_b32 s35, s33, 2
    s_add_u32 s35, s35, 9216
    v_and_b32 v4, 3, v3
    v_lshlrev_b32 v136, 4, v4
    v_add_u32 v136, s35, v136
    v_mul_u32_u24 v137, 576, v2
    v_lshl_add_u32 v137, v3, 2, v137
    s_lshl_b32 s35, s33, 6
    v_add_u32 v137, s35, v137
    s_lshl_b32 s35, s33, 4
    s_add_u32 s35, s35, 9216
    v_mov_b32 v138, s35
    s_lshl_b32 s69, s32, 13
    v_mov_b32 v18, 12288
    s_cmp_lg_u32 s33, 0
    s_nop 0
    s_cbranch_scc1 Lns_19
    s_mov_b32 s34, 0
Ln_20:
    buffer_load_dword v16, off, s[52:55], 0 sc1
    s_waitcnt vmcnt(0)
    v_readfirstlane_b32 s30, v16
    s_cmp_lg_u32 s30, 0
    s_nop 3
    s_cbranch_scc1 Lnd_21
    s_sleep 2
    s_add_u32 s34, s34, 1
    s_cmp_lt_u32 s34, 400000
    s_cbranch_scc1 Ln_20
Lnd_21:
    s_cmp_lg_u32 s33, 0
    s_cbranch_scc1 Lcp_22
    s_getreg_b32 s35, hwreg(HW_REG_XCC_ID)
    v_mov_b32 v16, s35
    v_mov_b32 v17, s30
    s_lshl_b32 s56, s31, 10
    s_lshl_b32 s35, s32, 3
    s_add_u32 s56, s56, s35
    s_add_u32 s56, s56, 0x60040
    s_mov_b64 exec, 1
    buffer_store_dwordx2 v[16:17], off, s[36:39], s56 sc1
    s_mov_b64 exec, -1
Lcp_22:
    s_waitcnt vmcnt(0)
    v_mov_b32 v16, s30
    ds_write_b32 v18, v16
    s_waitcnt lgkmcnt(0)
Lns_19:
    s_barrier
    ds_read_b32 v16, v18
    s_waitcnt lgkmcnt(0)
    v_readfirstlane_b32 s30, v16
    s_mov_b32 s56, s68
    s_add_u32 s59, s56, 4096
    buffer_load_dwordx4 v[32:35], v128, s[40:43], s56 offen offset:0 nt
    buffer_load_dwordx4 v[36:39], v128, s[40:43], s56 offen offset:64 nt
    buffer_load_dwordx4 v[40:43], v128, s[40:43], s56 offen offset:128 nt
    buffer_load_dwordx4 v[44:47], v128, s[40:43], s56 offen offset:192 nt
    buffer_load_dwordx4 v[48:51], v128, s[40:43], s59 offen offset:0 nt
    buffer_load_dwordx4 v[52:55], v128, s[40:43], s59 offen offset:64 nt
    buffer_load_dwordx4 v[56:59], v128, s[40:43], s59 offen offset:128 nt
    buffer_load_dwordx4 v[60:63], v128, s[40:43], s59 offen offset:192 nt
    buffer_load_dwordx4 v[96:99], v129, s[44:47], s56 offen offset:0 nt
    buffer_load_dwordx4 v[100:103], v129, s[44:47], s56 offen offset:256 nt
    buffer_load_dwordx4 v[104:107], v129, s[44:47], s56 offen offset:512 nt
    buffer_load_dwordx4 v[108:111], v129, s[44:47], s56 offen offset:768 nt
    buffer_load_dwordx4 v[112:115], v129, s[44:47], s59 offen offset:0 nt
    buffer_load_dwordx4 v[116:119], v129, s[44:47], s59 offen offset:256 nt
    buffer_load_dwordx4 v[120:123], v129, s[44:47], s59 offen offset:512 nt
    buffer_load_dwordx4 v[124:127], v129, s[44:47], s59 offen offset:768 nt
    s_waitcnt vmcnt(0)
    s_cmp_lg_u32 s33, 0
    s_cbranch_scc1 Lkv_23
    v_mov_b32 v4, s30
    v_mov_b32 v5, s30
    v_mov_b32 v6, 0
    s_lshl_b32 s35, s32, 7
    s_lshl_b32 s56, s31, 12
    s_add_u32 s56, s56, s77
    s_add_u32 s56, s56, s35
    s_add_u32 s56, s56, 0x70000
    s_mov_b64 exec, 1
    buffer_store_dwordx2 v[4:5], v6, s[36:39], s56 offen
    s_add_u32 s59, s56, 0x4000000
    buffer_store_dwordx2 v[4:5], v6, s[36:39], s59 offen sc1
    s_mov_b64 exec, -1
Lkv_23:
    v_perm_b32 v64, v100, v96, s60
    v_perm_b32 v68, v100, v96, s61
    v_perm_b32 v65, v108, v104, s60
    v_perm_b32 v69, v108, v104, s61
    v_perm_b32 v66, v116, v112, s60
    v_perm_b32 v70, v116, v112, s61
    v_perm_b32 v67, v124, v120, s60
    v_perm_b32 v71, v124, v120, s61
    v_perm_b32 v72, v101, v97, s60
    v_perm_b32 v76, v101, v97, s61
    v_perm_b32 v73, v109, v105, s60
    v_perm_b32 v77, v109, v105, s61
    v_perm_b32 v74, v117, v113, s60
    v_perm_b32 v78, v117, v113, s61
    v_perm_b32 v75, v125, v121, s60
    v_perm_b32 v79, v125, v121, s61
    v_perm_b32 v80, v102, v98, s60
    v_perm_b32 v84, v102, v98, s61
    v_perm_b32 v81, v110, v106, s60
    v_perm_b32 v85, v110, v106, s61
    v_perm_b32 v82, v118, v114, s60
    v_perm_b32 v86, v118, v114, s61
    v_perm_b32 v83, v126, v122, s60
    v_perm_b32 v87, v126, v122, s61
    v_perm_b32 v88, v103, v99, s60
    v_perm_b32 v92, v103, v99, s61
    v_perm_b32 v89, v111, v107, s60
    v_perm_b32 v93, v111, v107, s61
    v_perm_b32 v90, v119, v115, s60
    v_perm_b32 v94, v119, v115, s61
    v_perm_b32 v91, v127, v123, s60
    v_perm_b32 v95, v127, v123, s61
    s_mov_b32 s84, 0
    v_mov_b32 v22, 12292
    s_cmp_lg_u32 s33, 0
    s_nop 0
    s_cbranch_scc1 Lcw_24
    s_lshl_b32 s56, s31, 10
    s_add_u32 s56, s56, 0x60000
    v_lshlrev_b32 v20, 3, v1
    v_min_u32 v21, 14, v1
    v_lshlrev_b32 v21, 3, v21
    s_mov_b32 s34, 0
    s_nop 0
Lcwp_25:
    buffer_load_dwordx2 v[16:17], v20, s[36:39], s56 offen sc1
    buffer_load_dwordx2 v[18:19], v21, s[36:39], s56 offen offset:512 sc1
    s_waitcnt vmcnt(0)
    v_cmp_ne_u32 vcc, s30, v17
    v_cmp_ne_u32 s[70:71], s30, v19
    s_or_b64 vcc, vcc, s[70:71]
    s_nop 3
    s_cbranch_vccz Lcwd_26
    s_sleep 4
    s_add_u32 s34, s34, 1
    s_cmp_lt_u32 s34, 400000
    s_cbranch_scc1 Lcwp_25
Lcwd_26:
    s_getreg_b32 s35, hwreg(HW_REG_XCC_ID)
    v_cmp_ne_u32 vcc, s35, v16
    v_cmp_ne_u32 s[70:71], s35, v18
    s_or_b64 vcc, vcc, s[70:71]
    s_cmp_eq_u64 vcc, 0
    s_cselect_b32 s35, 1, 0
    s_cmp_lt_u32 s34, 400000
    s_cselect_b32 s35, s35, 0
    v_mov_b32 v16, s35
    ds_write_b32 v22, v16
    s_waitcnt lgkmcnt(0)
Lcw_24:
    s_barrier
    ds_read_b32 v16, v22
    s_waitcnt lgkmcnt(0)
    v_readfirstlane_b32 s84, v16
    s_nop 4
L_att_loop:
    s_lshl_b32 s57, s31, 7
    s_add_u32 s57, s57, s77
    s_add_u32 s57, s57, 0x50000
    s_cmp_lg_u32 s33, 0
    s_cbranch_scc1 Lgs_27
    s_mov_b32 s34, 0
    s_add_u32 s58, s57, 0x4000000
    s_cmp_lg_u32 s84, 0
    s_cselect_b32 s58, s57, s58
Lgp_28:
    s_and_b32 s35, s34, 15
    s_cmp_eq_u32 s35, 15
    s_cselect_b32 s56, s58, s57
    buffer_load_dword v4, off, s[36:39], s56 offset:4 sc1
    s_waitcnt vmcnt(0)
    v_readfirstlane_b32 s35, v4
    s_cmp_eq_u32 s35, s30
    s_nop 3
    s_cbranch_scc1 Lgs_27
    s_sleep 1
    s_add_u32 s34, s34, 1
    s_cmp_lt_u32 s34, s78
    s_cbranch_scc1 Lgp_28
Lgs_27:
    s_barrier
    s_lshl_b32 s57, s31, 11
    s_add_u32 s57, s57, s77
    s_mov_b32 s34, 0
    s_add_u32 s58, s57, 0x4000000
    s_cmp_lg_u32 s84, 0
    s_cselect_b32 s58, s57, s58
Lp_29:
    s_and_b32 s35, s34, 15
    s_cmp_eq_u32 s35, 15
    s_cselect_b32 s56, s58, s57
    buffer_load_dwordx4 v[96:99], v130, s[36:39], s56 offen offset:0 sc1
    buffer_load_dwordx4 v[100:103], v130, s[36:39], s56 offen offset:1024 sc1
    s_waitcnt vmcnt(0)
    v_min3_u32 v4, v97, v99, v101
    v_max3_u32 v5, v97, v99, v101
    v_min_u32 v4, v4, v103
    v_max_u32 v5, v5, v103
    v_cmp_ne_u32 vcc, s30, v4
    v_cmp_ne_u32 s[70:71], s30, v5
    s_or_b64 vcc, vcc, s[70:71]
    s_nop 3
    s_cbranch_vccz Ld_30
    s_add_u32 s34, s34, 1
    s_cmp_lt_u32 s34, s78
    s_cbranch_scc1 Lp_29
Ld_30:
    ds_write2_b32 v139, v96, v98 offset0:0 offset1:1
    ds_write2_b32 v139, v100, v102 offset0:128 offset1:129
    s_waitcnt lgkmcnt(0)
    ds_read_b128 v[16:19], v140 offset:0
    ds_read_b128 v[20:23], v140 offset:64
    ds_read_b128 v[24:27], v140 offset:128
    ds_read_b128 v[28:31], v140 offset:192
    s_waitcnt lgkmcnt(0)
    v_mfma_f32_16x16x32_bf16 v[8:11], v[32:35], v[16:19], 0
    v_mfma_f32_16x16x32_bf16 v[12:15], v[48:51], v[16:19], 0
    v_mfma_f32_16x16x32_bf16 v[8:11], v[36:39], v[20:23], v[8:11]
    v_mfma_f32_16x16x32_bf16 v[12:15], v[52:55], v[20:23], v[12:15]
    v_mfma_f32_16x16x32_bf16 v[8:11], v[40:43], v[24:27], v[8:11]
    v_mfma_f32_16x16x32_bf16 v[12:15], v[56:59], v[24:27], v[12:15]
    v_mfma_f32_16x16x32_bf16 v[8:11], v[44:47], v[28:31], v[8:11]
    v_mfma_f32_16x16x32_bf16 v[12:15], v[60:63], v[28:31], v[12:15]
    s_nop 6
    v_cvt_pk_bf16_f32 v16, v8, v9
    v_lshlrev_b32 v8, 16, v16
    v_and_b32 v9, 0xffff0000, v16
    v_cvt_pk_bf16_f32 v17, v10, v11
    v_lshlrev_b32 v10, 16, v17
    v_and_b32 v11, 0xffff0000, v17
    v_cvt_pk_bf16_f32 v18, v12, v13
    v_lshlrev_b32 v12, 16, v18
    v_and_b32 v13, 0xffff0000, v18
    v_cvt_pk_bf16_f32 v19, v14, v15
    v_lshlrev_b32 v14, 16, v19
    v_and_b32 v15, 0xffff0000, v19
    v_mul_f32 v8, s81, v8
    v_mul_f32 v9, s81, v9
    v_mul_f32 v10, s81, v10
    v_mul_f32 v11, s81, v11
    v_mul_f32 v12, s81, v12
    v_mul_f32 v13, s81, v13
    v_mul_f32 v14, s81, v14
    v_mul_f32 v15, s81, v15
    v_cvt_pk_bf16_f32 v16, v8, v9
    v_lshlrev_b32 v8, 16, v16
    v_and_b32 v9, 0xffff0000, v16
    v_cvt_pk_bf16_f32 v17, v10, v11
    v_lshlrev_b32 v10, 16, v17
    v_and_b32 v11, 0xffff0000, v17
    v_cvt_pk_bf16_f32 v18, v12, v13
    v_lshlrev_b32 v12, 16, v18
    v_and_b32 v13, 0xffff0000, v18
    v_cvt_pk_bf16_f32 v19, v14, v15
    v_lshlrev_b32 v14, 16, v19
    v_and_b32 v15, 0xffff0000, v19
    v_max3_f32 v24, v8, v9, v10
    v_max3_f32 v16, v11, v12, v13
    v_max3_f32 v24, v24, v14, v15
    v_max_f32 v24, v24, v16
    v_mov_b32 v16, v24
    s_nop 1
    v_permlane16_swap_b32 v24, v16
    v_max_f32 v24, v24, v16
    v_mov_b32 v16, v24
    s_nop 1
    v_permlane32_swap_b32 v24, v16
    v_max_f32 v24, v24, v16
    v_mul_f32 v16, s80, v24
    v_fma_f32 v8, v8, s80, -v16
    v_fma_f32 v9, v9, s80, -v16
    v_fma_f32 v10, v10, s80, -v16
    v_fma_f32 v11, v11, s80, -v16
    v_fma_f32 v12, v12, s80, -v16
    v_fma_f32 v13, v13, s80, -v16
    v_fma_f32 v14, v14, s80, -v16
    v_fma_f32 v15, v15, s80, -v16
    v_exp_f32 v8, v8
    v_exp_f32 v9, v9
    v_exp_f32 v10, v10
    v_exp_f32 v11, v11
    v_exp_f32 v12, v12
    v_exp_f32 v13, v13
    v_exp_f32 v14, v14
    v_exp_f32 v15, v15
    v_cvt_pk_bf16_f32 v4, v8, v9
    v_cvt_pk_bf16_f32 v5, v10, v11
    v_cvt_pk_bf16_f32 v6, v12, v13
    v_cvt_pk_bf16_f32 v7, v14, v15
    s_nop 1
    v_mfma_f32_16x16x32_bf16 v[96:99], v[4:7], v[64:67], 0
    v_mfma_f32_16x16x32_bf16 v[100:103], v[4:7], v[68:71], 0
    v_mfma_f32_16x16x32_bf16 v[104:107], v[4:7], v[72:75], 0
    v_mfma_f32_16x16x32_bf16 v[108:111], v[4:7], v[76:79], 0
    v_mfma_f32_16x16x32_bf16 v[112:115], v[4:7], v[80:83], 0
    v_mfma_f32_16x16x32_bf16 v[116:119], v[4:7], v[84:87], 0
    v_mfma_f32_16x16x32_bf16 v[120:123], v[4:7], v[88:91], 0
    v_mfma_f32_16x16x32_bf16 v[124:127], v[4:7], v[92:95], 0
    v_add_f32 v25, v8, v9
    v_add_f32 v16, v10, v11
    v_add_f32 v17, v12, v13
    v_add_f32 v18, v14, v15
    v_add_f32 v25, v25, v16
    v_add_f32 v17, v17, v18
    v_add_f32 v25, v25, v17
    v_mov_b32 v16, v25
    s_nop 1
    v_permlane16_swap_b32 v25, v16
    v_add_f32 v25, v25, v16
    v_mov_b32 v16, v25
    s_nop 1
    v_permlane32_swap_b32 v25, v16
    v_add_f32 v25, v25, v16
    s_mov_b64 exec, 0xf
    ds_write_b32 v136, v24
    ds_write_b32 v136, v25 offset:64
    s_mov_b64 exec, -1
    ds_write_b32 v135, v96 offset:0
    ds_write_b32 v135, v100 offset:288
    ds_write_b32 v135, v104 offset:576
    ds_write_b32 v135, v108 offset:864
    ds_write_b32 v135, v112 offset:1152
    ds_write_b32 v135, v116 offset:1440
    ds_write_b32 v135, v120 offset:1728
    ds_write_b32 v135, v124 offset:2016
    s_lshl_b32 s56, s31, 18
    s_add_u32 s56, s56, s77
    s_add_u32 s56, s56, 0x200000
    s_add_u32 s75, s56, 0x4000000
    s_add_u32 s57, s56, s69
    s_xor_b32 s76, s84, 1
    s_waitcnt lgkmcnt(0)
    s_barrier
    ds_read_b128 v[16:19], v138
    ds_read_b128 v[20:23], v138 offset:64
    ds_read_b32 v8, v137 offset:0
    ds_read_b32 v9, v137 offset:288
    ds_read_b32 v10, v137 offset:2304
    ds_read_b32 v11, v137 offset:2592
    ds_read_b32 v12, v137 offset:4608
    ds_read_b32 v13, v137 offset:4896
    ds_read_b32 v14, v137 offset:6912
    ds_read_b32 v15, v137 offset:7200
    v_mov_b32 v27, s30
    v_mov_b32 v29, s30
    v_mov_b32 v125, s30
    v_mov_b32 v127, s30
    s_waitcnt lgkmcnt(0)
    v_max3_f32 v124, v16, v17, v18
    v_max_f32 v124, v124, v19
    v_sub_f32 v16, v16, v124
    v_sub_f32 v17, v17, v124
    v_sub_f32 v18, v18, v124
    v_sub_f32 v19, v19, v124
    v_mul_f32 v16, s80, v16
    v_mul_f32 v17, s80, v17
    v_mul_f32 v18, s80, v18
    v_mul_f32 v19, s80, v19
    v_exp_f32 v16, v16
    v_exp_f32 v17, v17
    v_exp_f32 v18, v18
    v_exp_f32 v19, v19
    v_mul_f32 v126, v16, v20
    v_mul_f32 v26, v16, v8
    v_mul_f32 v28, v16, v9
    v_fmac_f32 v126, v17, v21
    v_fmac_f32 v26, v17, v10
    v_fmac_f32 v28, v17, v11
    v_fmac_f32 v126, v18, v22
    v_fmac_f32 v26, v18, v12
    v_fmac_f32 v28, v18, v13
    v_fmac_f32 v126, v19, v23
    v_fmac_f32 v26, v19, v14
    v_fmac_f32 v28, v19, v15
    buffer_store_dwordx4 v[26:29], v131, s[36:39], s56 offen
    s_mov_b64 exec, 0x5555
    buffer_store_dwordx4 v[124:127], v142, s[36:39], s56 offen
    s_mov_b64 exec, -1
    s_cmp_lg_u32 s33, 0
    s_cbranch_scc1 Lcs_31
    s_mov_b32 s34, 0
    s_add_u32 s58, s57, 0x4000000
    s_cmp_lg_u32 s84, 0
    s_cselect_b32 s58, s57, s58
Lp_32:
    s_and_b32 s35, s34, 15
    s_cmp_eq_u32 s35, 15
    s_cselect_b32 s56, s58, s57
    s_cbranch_scc0 Lh_34
    s_cmp_eq_u32 s76, 0
    s_cbranch_scc1 Lgst_35
    s_mov_b64 exec, 0x5555
    buffer_store_dwordx4 v[124:127], v142, s[36:39], s75 offen sc1
    s_mov_b64 exec, -1
    buffer_store_dwordx4 v[26:29], v131, s[36:39], s75 offen sc1
    s_mov_b32 s76, 0
    s_nop 0
Lgst_35:
Lh_34:
    buffer_load_dwordx4 v[96:99], v132, s[36:39], s56 offen offset:0 sc1
    buffer_load_dwordx4 v[100:103], v132, s[36:39], s56 offen offset:1024 sc1
    buffer_load_dwordx4 v[104:107], v132, s[36:39], s56 offen offset:2048 sc1
    buffer_load_dwordx4 v[108:111], v132, s[36:39], s56 offen offset:3072 sc1
    buffer_load_dwordx4 v[112:115], v133, s[36:39], s56 offen sc1
    buffer_load_dwordx2 v[116:117], v143, s[36:39], s56 offen offset:0 sc1
    buffer_load_dwordx2 v[118:119], v143, s[36:39], s56 offen offset:128 sc1
    buffer_load_dwordx2 v[120:121], v143, s[36:39], s56 offen offset:256 sc1
    buffer_load_dwordx2 v[122:123], v143, s[36:39], s56 offen offset:384 sc1
    s_waitcnt vmcnt(0)
    v_min3_u32 v4, v97, v99, v101
    v_max3_u32 v5, v97, v99, v101
    v_min3_u32 v4, v4, v103, v105
    v_max3_u32 v5, v5, v103, v105
    v_min3_u32 v4, v4, v107, v109
    v_max3_u32 v5, v5, v107, v109
    v_min3_u32 v4, v4, v111, v113
    v_max3_u32 v5, v5, v111, v113
    v_min3_u32 v4, v4, v115, v117
    v_max3_u32 v5, v5, v115, v117
    v_min3_u32 v4, v4, v119, v121
    v_max3_u32 v5, v5, v119, v121
    v_min_u32 v4, v4, v123
    v_max_u32 v5, v5, v123
    v_cmp_ne_u32 vcc, s30, v4
    v_cmp_ne_u32 s[70:71], s30, v5
    s_or_b64 vcc, vcc, s[70:71]
    s_nop 3
    s_cbranch_vccz Ld_33
    s_add_u32 s34, s34, 1
    s_cmp_lt_u32 s34, s78
    s_cbranch_scc1 Lp_32
Ld_33:
    v_mov_b32 v24, v112
    s_lshl_b32 s56, s31, 11
    s_add_u32 s56, s56, s77
    s_add_u32 s56, s56, 0x10000
    v_mov_b32 v5, s30
    v_max_f32_dpp v24, v24, v24 row_ror:8 row_mask:0xf bank_mask:0xf
    s_nop 1
    v_max_f32_dpp v24, v24, v24 row_ror:4 row_mask:0xf bank_mask:0xf
    s_nop 1
    v_max_f32_dpp v24, v24, v24 row_ror:2 row_mask:0xf bank_mask:0xf
    s_nop 1
    v_max_f32_dpp v24, v24, v24 row_ror:1 row_mask:0xf bank_mask:0xf
    v_mov_b32 v16, v24
    s_nop 1
    v_permlane16_swap_b32 v24, v16
    v_max_f32 v24, v24, v16
    v_sub_f32 v16, v112, v24
    v_sub_f32 v20, v116, v24
    v_sub_f32 v21, v118, v24
    v_sub_f32 v22, v120, v24
    v_sub_f32 v23, v122, v24
    v_mul_f32 v16, s80, v16
    v_mul_f32 v20, s80, v20
    v_mul_f32 v21, s80, v21
    v_mul_f32 v22, s80, v22
    v_mul_f32 v23, s80, v23
    v_exp_f32 v16, v16
    v_exp_f32 v20, v20
    v_exp_f32 v21, v21
    v_exp_f32 v22, v22
    v_exp_f32 v23, v23
    v_mul_f32 v19, v16, v114
    v_mul_f32 v17, v20, v96
    v_mul_f32 v18, v20, v98
    v_fmac_f32 v17, v21, v100
    v_fmac_f32 v18, v21, v102
    v_fmac_f32 v17, v22, v104
    v_fmac_f32 v18, v22, v106
    v_fmac_f32 v17, v23, v108
    v_fmac_f32 v18, v23, v110
    v_add_f32_dpp v19, v19, v19 row_ror:8 row_mask:0xf bank_mask:0xf
    v_add_f32_dpp v17, v17, v17 row_ror:8 row_mask:0xf bank_mask:0xf
    v_add_f32_dpp v18, v18, v18 row_ror:8 row_mask:0xf bank_mask:0xf
    v_add_f32_dpp v19, v19, v19 row_ror:4 row_mask:0xf bank_mask:0xf
    s_nop 1
    v_add_f32_dpp v19, v19, v19 row_ror:2 row_mask:0xf bank_mask:0xf
    s_nop 1
    v_add_f32_dpp v19, v19, v19 row_ror:1 row_mask:0xf bank_mask:0xf
    v_mov_b32 v20, v17
    v_mov_b32 v21, v18
    v_mov_b32 v22, v19
    v_permlane16_swap_b32 v17, v20
    v_permlane16_swap_b32 v18, v21
    v_permlane16_swap_b32 v19, v22
    v_add_f32 v17, v17, v20
    v_add_f32 v18, v18, v21
    v_add_f32 v19, v19, v22
    v_mov_b32 v20, v17
    v_mov_b32 v21, v18
    s_nop 0
    v_permlane32_swap_b32 v17, v20
    v_permlane32_swap_b32 v18, v21
    v_add_f32 v17, v17, v20
    v_add_f32 v18, v18, v21
    v_rcp_f32 v19, v19
    s_nop 0
    v_mul_f32 v17, v17, v19
    v_mul_f32 v18, v18, v19
    v_cvt_pk_bf16_f32 v4, v17, v18
    s_mov_b64 exec, 0xff
    buffer_store_dwordx2 v[4:5], v134, s[36:39], s56 offen
    s_add_u32 s59, s56, 0x4000000
    buffer_store_dwordx2 v[4:5], v134, s[36:39], s59 offen sc1
    s_mov_b64 exec, -1
Lcs_31:
    s_cmp_eq_u32 s76, 0
    s_cbranch_scc1 Lgst_36
    s_mov_b64 exec, 0x5555
    buffer_store_dwordx4 v[124:127], v142, s[36:39], s75 offen sc1
    s_mov_b64 exec, -1
    buffer_store_dwordx4 v[26:29], v131, s[36:39], s75 offen sc1
    s_mov_b32 s76, 0
    s_nop 0
Lgst_36:
    s_cmp_lg_u32 s78, 0
    s_cbranch_scc1 Lt_37
    s_mov_b32 s77, 0x0
    s_mov_b32 s78, 400000
    s_branch L_att_loop
Lt_37:
    s_bitcmp0_b32 s30, 0
    s_cbranch_scc1 L_end
    s_add_u32 s30, s30, 1
    s_branch L_att_loop
L_wo:
    s_sub_u32 s32, s2, 376
    s_lshr_b32 s32, s32, 3
    s_mov_b32 s40, s12
    s_and_b32 s41, s13, 0xffff
    s_mov_b32 s42, 0x400000
    s_mov_b32 s43, 0x00020000
    v_lshrrev_b32 v4, 2, v3
    v_and_b32 v5, 3, v3
    v_lshlrev_b32 v48, 15, v4
    v_lshl_add_u32 v48, v2, 13, v48
    v_lshl_add_u32 v48, v5, 3, v48
    v_mov_b32 v98, 12288
    s_cmp_lg_u32 s33, 0
    s_nop 0
    s_cbranch_scc1 Lns_38
    s_mov_b32 s34, 0
Ln_39:
    buffer_load_dword v96, off, s[52:55], 0 sc1
    s_waitcnt vmcnt(0)
    v_readfirstlane_b32 s30, v96
    s_cmp_lg_u32 s30, 0
    s_nop 3
    s_cbranch_scc1 Lnd_40
    s_sleep 2
    s_add_u32 s34, s34, 1
    s_cmp_lt_u32 s34, 400000
    s_cbranch_scc1 Ln_39
Lnd_40:
    s_cmp_lg_u32 s33, 0
    s_cbranch_scc1 Lcp_41
    s_getreg_b32 s35, hwreg(HW_REG_XCC_ID)
    v_mov_b32 v96, s35
    v_mov_b32 v97, s30
    s_lshl_b32 s56, s31, 10
    s_lshl_b32 s35, s32, 3
    s_add_u32 s56, s56, s35
    s_add_u32 s56, s56, 0x60140
    s_mov_b64 exec, 1
    buffer_store_dwordx2 v[96:97], off, s[36:39], s56 sc1
    s_mov_b64 exec, -1
Lcp_41:
    s_waitcnt vmcnt(0)
    v_mov_b32 v96, s30
    ds_write_b32 v98, v96
    s_waitcnt lgkmcnt(0)
Lns_38:
    s_barrier
    ds_read_b32 v96, v98
    s_waitcnt lgkmcnt(0)
    v_readfirstlane_b32 s30, v96
    s_lshl_b32 s75, s32, 7
    s_lshl_b32 s57, s31, 12
    s_add_u32 s57, s57, s77
    s_add_u32 s57, s57, s75
    s_add_u32 s57, s57, 0x70000
    s_cmp_lg_u32 s33, 0
    s_cbranch_scc1 Lgs_42
    s_mov_b32 s34, 0
    s_add_u32 s58, s57, 0x4000000
    s_cmp_lg_u32 s84, 0
    s_cselect_b32 s58, s57, s58
Lgp_43:
    s_and_b32 s35, s34, 15
    s_cmp_eq_u32 s35, 15
    s_cselect_b32 s56, s58, s57
    buffer_load_dword v96, off, s[36:39], s56 offset:4 sc1
    s_waitcnt vmcnt(0)
    v_readfirstlane_b32 s35, v96
    s_cmp_eq_u32 s35, s30
    s_nop 3
    s_cbranch_scc1 Lgs_42
    s_sleep 1
    s_add_u32 s34, s34, 1
    s_cmp_lt_u32 s34, s78
    s_cbranch_scc1 Lgp_43
Lgs_42:
    s_barrier
    s_lshl_b32 s56, s31, 19
    s_lshl_b32 s35, s33, 17
    s_add_u32 s56, s56, s35
    s_lshl_b32 s35, s32, 5
    s_add_u32 s56, s56, s35
    s_add_u32 s59, s56, 4096
    buffer_load_dwordx2 v[64:65], v48, s[40:43], s56 offen offset:0 nt
    buffer_load_dwordx2 v[66:67], v48, s[40:43], s56 offen offset:1024 nt
    buffer_load_dwordx2 v[68:69], v48, s[40:43], s56 offen offset:2048 nt
    buffer_load_dwordx2 v[70:71], v48, s[40:43], s56 offen offset:3072 nt
    buffer_load_dwordx2 v[72:73], v48, s[40:43], s59 offen offset:0 nt
    buffer_load_dwordx2 v[74:75], v48, s[40:43], s59 offen offset:1024 nt
    buffer_load_dwordx2 v[76:77], v48, s[40:43], s59 offen offset:2048 nt
    buffer_load_dwordx2 v[78:79], v48, s[40:43], s59 offen offset:3072 nt
    v_lshlrev_b32 v49, 3, v0
    s_lshl_b32 s35, s33, 8
    s_add_u32 s35, s35, 1024
    v_lshlrev_b32 v54, 2, v1
    v_add_u32 v54, s35, v54
    v_lshlrev_b32 v55, 4, v2
    v_lshl_add_u32 v55, v4, 6, v55
    v_add_u32 v55, s35, v55
    s_mov_b32 s3, 0x03020107
    s_mov_b32 s62, 0x03020106
    s_mov_b32 s63, 0x03020105
    s_mov_b32 s72, 0x00040c0c
    s_mov_b32 s73, 0x0302040c
    s_lshl_b32 s35, s32, 6
    v_lshlrev_b32 v50, 2, v3
    v_add_u32 v50, s35, v50
    s_lshl_b32 s35, s32, 8
    v_lshlrev_b32 v56, 2, v1
    v_add_u32 v56, s35, v56
    s_lshl_b32 s35, s32, 9
    v_lshlrev_b32 v51, 3, v1
    v_add_u32 v51, s35, v51
    s_lshl_b32 s35, s33, 8
    v_lshlrev_b32 v52, 6, v2
    v_lshl_add_u32 v52, v5, 4, v52
    v_add_u32 v52, s35, v52
    v_lshlrev_b32 v53, 8, v2
    v_lshl_add_u32 v53, v3, 2, v53
    s_waitcnt vmcnt(0)
    v_perm_b32 v32, v66, v64, s60
    v_perm_b32 v36, v66, v64, s61
    v_perm_b32 v40, v67, v65, s60
    v_perm_b32 v44, v67, v65, s61
    v_perm_b32 v33, v70, v68, s60
    v_perm_b32 v37, v70, v68, s61
    v_perm_b32 v41, v71, v69, s60
    v_perm_b32 v45, v71, v69, s61
    v_perm_b32 v34, v74, v72, s60
    v_perm_b32 v38, v74, v72, s61
    v_perm_b32 v42, v75, v73, s60
    v_perm_b32 v46, v75, v73, s61
    v_perm_b32 v35, v78, v76, s60
    v_perm_b32 v39, v78, v76, s61
    v_perm_b32 v43, v79, v77, s60
    v_perm_b32 v47, v79, v77, s61
    s_mov_b32 s84, 0
    v_mov_b32 v102, 12292
    s_cmp_lg_u32 s33, 0
    s_nop 0
    s_cbranch_scc1 Lcw_44
    s_lshl_b32 s56, s31, 10
    s_add_u32 s56, s56, 0x60000
    v_lshlrev_b32 v100, 3, v1
    v_min_u32 v101, 14, v1
    v_lshlrev_b32 v101, 3, v101
    s_mov_b32 s34, 0
    s_nop 0
Lcwp_45:
    buffer_load_dwordx2 v[96:97], v100, s[36:39], s56 offen sc1
    buffer_load_dwordx2 v[98:99], v101, s[36:39], s56 offen offset:512 sc1
    s_waitcnt vmcnt(0)
    v_cmp_ne_u32 vcc, s30, v97
    v_cmp_ne_u32 s[70:71], s30, v99
    s_or_b64 vcc, vcc, s[70:71]
    s_nop 3
    s_cbranch_vccz Lcwd_46
    s_sleep 4
    s_add_u32 s34, s34, 1
    s_cmp_lt_u32 s34, 400000
    s_cbranch_scc1 Lcwp_45
Lcwd_46:
    s_getreg_b32 s35, hwreg(HW_REG_XCC_ID)
    v_cmp_ne_u32 vcc, s35, v96
    v_cmp_ne_u32 s[70:71], s35, v98
    s_or_b64 vcc, vcc, s[70:71]
    s_cmp_eq_u64 vcc, 0
    s_cselect_b32 s35, 1, 0
    s_cmp_lt_u32 s34, 400000
    s_cselect_b32 s35, s35, 0
    v_mov_b32 v96, s35
    ds_write_b32 v102, v96
    s_waitcnt lgkmcnt(0)
Lcw_44:
    s_barrier
    ds_read_b32 v96, v102
    s_waitcnt lgkmcnt(0)
    v_readfirstlane_b32 s84, v96
    s_nop 4
L_wo_loop:
    s_lshl_b32 s57, s31, 18
    s_add_u32 s57, s57, s77
    s_add_u32 s57, s57, 0x201000
    s_cmp_lg_u32 s33, 0
    s_cbranch_scc1 Lgs_47
    s_mov_b32 s34, 0
    s_add_u32 s58, s57, 0x4000000
    s_cmp_lg_u32 s84, 0
    s_cselect_b32 s58, s57, s58
Lgp_48:
    s_and_b32 s35, s34, 15
    s_cmp_eq_u32 s35, 15
    s_cselect_b32 s56, s58, s57
    buffer_load_dword v96, off, s[36:39], s56 offset:4 sc1
    s_waitcnt vmcnt(0)
    v_readfirstlane_b32 s35, v96
    s_cmp_eq_u32 s35, s30
    s_nop 3
    s_cbranch_scc1 Lgs_47
    s_sleep 1
    s_add_u32 s34, s34, 1
    s_cmp_lt_u32 s34, s78
    s_cbranch_scc1 Lgp_48
Lgs_47:
    s_barrier
    s_lshl_b32 s57, s31, 11
    s_add_u32 s57, s57, s77
    s_add_u32 s57, s57, 0x10000
    s_mov_b32 s34, 0
    s_add_u32 s58, s57, 0x4000000
    s_cmp_lg_u32 s84, 0
    s_cselect_b32 s58, s57, s58
Lp_49:
    s_and_b32 s35, s34, 15
    s_cmp_eq_u32 s35, 15
    s_cselect_b32 s56, s58, s57
    buffer_load_dwordx2 v[64:65], v49, s[36:39], s56 offen sc1
    s_waitcnt vmcnt(0)
    v_cmp_ne_u32 vcc, s30, v65
    s_nop 4
    s_cbranch_vccz Ld_50
    s_add_u32 s34, s34, 1
    s_cmp_lt_u32 s34, s78
    s_cbranch_scc1 Lp_49
Ld_50:
    s_cmp_lg_u32 s32, 0
    s_cbranch_scc1 Lan_51
    s_cmp_lg_u32 s33, 3
    s_cbranch_scc1 Lan_51
    v_mov_b32 v112, s30
    v_mov_b32 v113, s30
    v_mov_b32 v114, 0
    s_lshl_b32 s56, s31, 7
    s_add_u32 s56, s56, s77
    s_add_u32 s56, s56, 0x52000
    s_mov_b64 exec, 1
    buffer_store_dwordx2 v[112:113], v114, s[36:39], s56 offen
    s_add_u32 s59, s56, 0x4000000
    buffer_store_dwordx2 v[112:113], v114, s[36:39], s59 offen sc1
    s_mov_b64 exec, -1
Lan_51:
    ds_write_b32 v54, v64
    s_waitcnt lgkmcnt(0)
    ds_read_b128 v[8:11], v55
    s_lshl_b32 s56, s31, 11
    s_add_u32 s56, s56, s77
    s_add_u32 s56, s56, 0xc0000
    s_waitcnt lgkmcnt(0)
    v_mfma_f32_16x16x32_bf16 v[12:15], v[8:11], v[32:35], 0
    v_mfma_f32_16x16x32_bf16 v[16:19], v[8:11], v[36:39], 0
    v_mfma_f32_16x16x32_bf16 v[20:23], v[8:11], v[40:43], 0
    v_mfma_f32_16x16x32_bf16 v[24:27], v[8:11], v[44:47], 0
    s_mov_b32 exec_lo, 0x00f0000f
    s_mov_b32 exec_hi, 0xf0000f00
    s_nop 3
    ds_write2_b32 v52, v12, v16 offset0:0 offset1:1
    s_nop 0
    ds_write2_b32 v52, v20, v24 offset0:2 offset1:3
    s_mov_b64 exec, -1
    s_waitcnt lgkmcnt(0)
    s_barrier
    s_cmp_lg_u32 s33, 0
    s_cbranch_scc1 Lred_53
    ds_read_b32 v96, v53 offset:0
    ds_read_b32 v97, v53 offset:64
    ds_read_b32 v98, v53 offset:128
    ds_read_b32 v99, v53 offset:192
    s_waitcnt lgkmcnt(0)
    v_add_f32 v96, v96, v97
    v_add_f32 v98, v98, v99
    v_add_f32 v100, v96, v98
    v_mov_b32 v96, v100
    s_nop 1
    v_permlane16_swap_b32 v100, v96
    v_add_f32 v100, v100, v96
    v_mov_b32 v96, v100
    s_nop 1
    v_permlane32_swap_b32 v100, v96
    v_add_f32 v100, v100, v96
    s_nop 1
    v_mov_b32_dpp v96, v100 quad_perm:[1,1,1,1] row_mask:0xf bank_mask:0xf
    v_mov_b32_dpp v97, v100 quad_perm:[2,2,2,2] row_mask:0xf bank_mask:0xf
    v_mov_b32_dpp v98, v100 quad_perm:[3,3,3,3] row_mask:0xf bank_mask:0xf
    v_mov_b32 v107, s30
    v_perm_b32 v104, v98, v100, s3
    v_perm_b32 v105, v98, v96, s62
    v_perm_b32 v106, v98, v97, s63
    s_mov_b64 exec, 0x1111
    buffer_store_dwordx4 v[104:107], v50, s[36:39], s56 offen sc1
    s_add_u32 s56, s56, 0x4000
    buffer_store_dwordx4 v[104:107], v50, s[36:39], s56 offen sc1
    s_add_u32 s56, s56, 0x4000
    buffer_store_dwordx4 v[104:107], v50, s[36:39], s56 offen sc1
    s_add_u32 s56, s56, 0x4000
    buffer_store_dwordx4 v[104:107], v50, s[36:39], s56 offen sc1
    s_add_u32 s56, s56, 0x4000
    buffer_store_dwordx4 v[104:107], v50, s[36:39], s56 offen sc1
    s_add_u32 s56, s56, 0x4000
    buffer_store_dwordx4 v[104:107], v50, s[36:39], s56 offen sc1
    s_add_u32 s56, s56, 0x4000
    buffer_store_dwordx4 v[104:107], v50, s[36:39], s56 offen sc1
    s_add_u32 s56, s56, 0x4000
    buffer_store_dwordx4 v[104:107], v50, s[36:39], s56 offen sc1
    s_mov_b64 exec, -1
    s_nop 0
    s_branch Lwo_52
Lred_53:
    s_cmp_lg_u32 s33, 1
    s_cbranch_scc1 Lwo_52
    s_cmp_ge_u32 s32, 8
    s_cbranch_scc1 Lwo_52
    s_lshl_b32 s57, s31, 15
    s_add_u32 s57, s57, s77
    s_add_u32 s57, s57, 0x80000
    s_mov_b32 s34, 0
    s_add_u32 s58, s57, 0x4000000
    s_cmp_lg_u32 s84, 0
    s_cselect_b32 s58, s57, s58
Lp_54:
    s_and_b32 s35, s34, 15
    s_cmp_eq_u32 s35, 15
    s_cselect_b32 s56, s58, s57
    s_add_u32 s59, s56, 0x0
    buffer_load_dwordx2 v[64:65], v51, s[36:39], s59 offen sc1
    s_add_u32 s59, s56, 0x1000
    buffer_load_dwordx2 v[66:67], v51, s[36:39], s59 offen sc1
    s_add_u32 s59, s56, 0x2000
    buffer_load_dwordx2 v[68:69], v51, s[36:39], s59 offen sc1
    s_add_u32 s59, s56, 0x3000
    buffer_load_dwordx2 v[70:71], v51, s[36:39], s59 offen sc1
    s_add_u32 s59, s56, 0x4000
    buffer_load_dwordx2 v[72:73], v51, s[36:39], s59 offen sc1
    s_add_u32 s59, s56, 0x5000
    buffer_load_dwordx2 v[74:75], v51, s[36:39], s59 offen sc1
    s_add_u32 s59, s56, 0x6000
    buffer_load_dwordx2 v[76:77], v51, s[36:39], s59 offen sc1
    s_waitcnt vmcnt(0)
    v_min3_u32 v4, v65, v67, v69
    v_max3_u32 v5, v65, v67, v69
    v_min3_u32 v4, v4, v71, v73
    v_max3_u32 v5, v5, v71, v73
    v_min3_u32 v4, v4, v75, v77
    v_max3_u32 v5, v5, v75, v77
    v_cmp_ne_u32 vcc, s30, v4
    v_cmp_ne_u32 s[70:71], s30, v5
    s_or_b64 vcc, vcc, s[70:71]
    s_nop 3
    s_cbranch_vccz Ld_55
    s_add_u32 s34, s34, 1
    s_cmp_lt_u32 s34, s78
    s_cbranch_scc1 Lp_54
Ld_55:
    s_cmp_lg_u32 s32, 0
    s_cbranch_scc1 Lan_56
    s_cmp_lg_u32 s33, 1
    s_cbranch_scc1 Lan_56
    v_mov_b32 v112, s30
    v_mov_b32 v113, s30
    v_mov_b32 v114, 0
    s_lshl_b32 s56, s31, 7
    s_add_u32 s56, s56, s77
    s_add_u32 s56, s56, 0x53000
    s_mov_b64 exec, 1
    buffer_store_dwordx2 v[112:113], v114, s[36:39], s56 offen
    s_add_u32 s59, s56, 0x4000000
    buffer_store_dwordx2 v[112:113], v114, s[36:39], s59 offen sc1
    s_mov_b64 exec, -1
Lan_56:
    s_lshl_b32 s56, s31, 11
    s_add_u32 s56, s56, s77
    s_add_u32 s56, s56, 0xe0000
    v_add_f32 v100, v64, v66
    v_add_f32 v100, v100, v68
    v_add_f32 v100, v100, v70
    v_add_f32 v100, v100, v72
    v_add_f32 v100, v100, v74
    v_add_f32 v100, v100, v76
    s_nop 1
    v_mov_b32_dpp v96, v100 quad_perm:[1,1,1,1] row_mask:0xf bank_mask:0xf
    v_mov_b32_dpp v97, v100 quad_perm:[2,2,2,2] row_mask:0xf bank_mask:0xf
    v_mov_b32_dpp v98, v100 quad_perm:[3,3,3,3] row_mask:0xf bank_mask:0xf
    v_mov_b32 v107, s30
    v_perm_b32 v104, v98, v100, s3
    v_perm_b32 v105, v98, v96, s62
    v_perm_b32 v106, v98, v97, s63
    s_mov_b32 exec_lo, 0x11111111
    s_mov_b32 exec_hi, 0x11111111
    buffer_store_dwordx4 v[104:107], v56, s[36:39], s56 offen sc1
    s_add_u32 s56, s56, 0x4000
    buffer_store_dwordx4 v[104:107], v56, s[36:39], s56 offen sc1
    s_add_u32 s56, s56, 0x4000
    buffer_store_dwordx4 v[104:107], v56, s[36:39], s56 offen sc1
    s_add_u32 s56, s56, 0x4000
    buffer_store_dwordx4 v[104:107], v56, s[36:39], s56 offen sc1
    s_add_u32 s56, s56, 0x4000
    buffer_store_dwordx4 v[104:107], v56, s[36:39], s56 offen sc1
    s_add_u32 s56, s56, 0x4000
    buffer_store_dwordx4 v[104:107], v56, s[36:39], s56 offen sc1
    s_add_u32 s56, s56, 0x4000
    buffer_store_dwordx4 v[104:107], v56, s[36:39], s56 offen sc1
    s_add_u32 s56, s56, 0x4000
    buffer_store_dwordx4 v[104:107], v56, s[36:39], s56 offen sc1
    s_mov_b64 exec, -1
    s_nop 0
Lwo_52:
    s_cmp_lg_u32 s78, 0
    s_cbranch_scc1 Lt_57
    s_mov_b32 s77, 0x0
    s_mov_b32 s78, 400000
    s_branch L_wo_loop
Lt_57:
    s_bitcmp0_b32 s30, 0
    s_cbranch_scc1 L_end
    s_add_u32 s30, s30, 1
    s_branch L_wo_loop
L_ffn:
    s_sub_u32 s32, s2, 320
    s_lshr_b32 s32, s32, 3
    s_mul_i32 s69, s31, 7
    s_add_u32 s69, s69, s32
    s_lshl_b32 s68, s32, 12
    s_mov_b32 s40, s16
    s_and_b32 s41, s17, 0xffff
    s_mov_b32 s42, 0x1c0000
    s_mov_b32 s43, 0x00020000
    s_mov_b32 s44, s20
    s_and_b32 s45, s21, 0xffff
    s_mov_b32 s46, 0x1c0000
    s_mov_b32 s47, 0x00020000
    s_mov_b32 s64, s18
    s_and_b32 s65, s19, 0xffff
    s_mov_b32 s66, 0xe00
    s_mov_b32 s67, 0x00020000
    v_lshlrev_b32 v5, 2, v0
    v_lshlrev_b32 v6, 3, v0
    v_and_b32 v4, 1, v1
    v_lshlrev_b32 v4, 13, v4
    v_lshrrev_b32 v7, 1, v0
    v_lshl_add_u32 v7, v7, 4, v4
    s_mov_b32 s3, 0x03020107
    s_mov_b32 s62, 0x03020106
    s_mov_b32 s63, 0x03020105
    s_mov_b32 s72, 0x00040c0c
    s_mov_b32 s73, 0x0302040c
    v_mov_b32 v18, 12288
    s_cmp_lg_u32 s33, 0
    s_nop 0
    s_cbranch_scc1 Lns_58
    s_mov_b32 s34, 0
Ln_59:
    buffer_load_dword v16, off, s[52:55], 0 sc1
    s_waitcnt vmcnt(0)
    v_readfirstlane_b32 s30, v16
    s_cmp_lg_u32 s30, 0
    s_nop 3
    s_cbranch_scc1 Lnd_60
    s_sleep 2
    s_add_u32 s34, s34, 1
    s_cmp_lt_u32 s34, 400000
    s_cbranch_scc1 Ln_59
Lnd_60:
    s_cmp_lg_u32 s33, 0
    s_cbranch_scc1 Lcp_61
    s_getreg_b32 s35, hwreg(HW_REG_XCC_ID)
    v_mov_b32 v16, s35
    v_mov_b32 v17, s30
    s_lshl_b32 s56, s31, 10
    s_lshl_b32 s35, s32, 3
    s_add_u32 s56, s56, s35
    s_add_u32 s56, s56, 0x60240
    s_mov_b64 exec, 1
    buffer_store_dwordx2 v[16:17], off, s[36:39], s56 sc1
    s_mov_b64 exec, -1
Lcp_61:
    s_waitcnt vmcnt(0)
    v_mov_b32 v16, s30
    ds_write_b32 v18, v16
    s_waitcnt lgkmcnt(0)
Lns_58:
    s_barrier
    ds_read_b32 v16, v18
    s_waitcnt lgkmcnt(0)
    v_readfirstlane_b32 s30, v16
    s_lshl_b32 s75, s32, 7
    s_lshl_b32 s57, s31, 12
    s_add_u32 s57, s57, s77
    s_add_u32 s57, s57, s75
    s_add_u32 s57, s57, 0x70000
    s_cmp_lg_u32 s33, 0
    s_cbranch_scc1 Lgs_62
    s_mov_b32 s34, 0
    s_add_u32 s58, s57, 0x4000000
    s_cmp_lg_u32 s84, 0
    s_cselect_b32 s58, s57, s58
Lgp_63:
    s_and_b32 s35, s34, 15
    s_cmp_eq_u32 s35, 15
    s_cselect_b32 s56, s58, s57
    buffer_load_dword v16, off, s[36:39], s56 offset:4 sc1
    s_waitcnt vmcnt(0)
    v_readfirstlane_b32 s35, v16
    s_cmp_eq_u32 s35, s30
    s_nop 3
    s_cbranch_scc1 Lgs_62
    s_sleep 1
    s_add_u32 s34, s34, 1
    s_cmp_lt_u32 s34, s78
    s_cbranch_scc1 Lgp_63
Lgs_62:
    s_barrier
    v_and_b32 v4, 31, v1
    v_lshlrev_b32 v4, 1, v4
    s_lshl_b32 s35, s69, 6
    buffer_load_ushort v15, v4, s[64:67], s35 offen
    s_mov_b32 s35, 28672
    v_mul_lo_u32 v8, v2, s35
    v_lshl_add_u32 v8, v3, 2, v8
    s_mul_i32 s56, s33, 458752
    s_lshl_b32 s35, s69, 6
    s_add_u32 s56, s56, s35
    s_add_u32 s35, s56, 0x0
    buffer_load_dword v40, v8, s[40:43], s35 offen nt
    s_add_u32 s35, s56, 0xe00
    buffer_load_dword v41, v8, s[40:43], s35 offen nt
    s_add_u32 s35, s56, 0x1c00
    buffer_load_dword v42, v8, s[40:43], s35 offen nt
    s_add_u32 s35, s56, 0x2a00
    buffer_load_dword v43, v8, s[40:43], s35 offen nt
    s_add_u32 s35, s56, 0x3800
    buffer_load_dword v44, v8, s[40:43], s35 offen nt
    s_add_u32 s35, s56, 0x4600
    buffer_load_dword v45, v8, s[40:43], s35 offen nt
    s_add_u32 s35, s56, 0x5400
    buffer_load_dword v46, v8, s[40:43], s35 offen nt
    s_add_u32 s35, s56, 0x6200
    buffer_load_dword v47, v8, s[40:43], s35 offen nt
    s_add_u32 s35, s56, 0x1c000
    buffer_load_dword v48, v8, s[40:43], s35 offen nt
    s_add_u32 s35, s56, 0x1ce00
    buffer_load_dword v49, v8, s[40:43], s35 offen nt
    s_add_u32 s35, s56, 0x1dc00
    buffer_load_dword v50, v8, s[40:43], s35 offen nt
    s_add_u32 s35, s56, 0x1ea00
    buffer_load_dword v51, v8, s[40:43], s35 offen nt
    s_add_u32 s35, s56, 0x1f800
    buffer_load_dword v52, v8, s[40:43], s35 offen nt
    s_add_u32 s35, s56, 0x20600
    buffer_load_dword v53, v8, s[40:43], s35 offen nt
    s_add_u32 s35, s56, 0x21400
    buffer_load_dword v54, v8, s[40:43], s35 offen nt
    s_add_u32 s35, s56, 0x22200
    buffer_load_dword v55, v8, s[40:43], s35 offen nt
    s_add_u32 s35, s56, 0x38000
    buffer_load_dword v56, v8, s[40:43], s35 offen nt
    s_add_u32 s35, s56, 0x38e00
    buffer_load_dword v57, v8, s[40:43], s35 offen nt
    s_add_u32 s35, s56, 0x39c00
    buffer_load_dword v58, v8, s[40:43], s35 offen nt
    s_add_u32 s35, s56, 0x3aa00
    buffer_load_dword v59, v8, s[40:43], s35 offen nt
    s_add_u32 s35, s56, 0x3b800
    buffer_load_dword v60, v8, s[40:43], s35 offen nt
    s_add_u32 s35, s56, 0x3c600
    buffer_load_dword v61, v8, s[40:43], s35 offen nt
    s_add_u32 s35, s56, 0x3d400
    buffer_load_dword v62, v8, s[40:43], s35 offen nt
    s_add_u32 s35, s56, 0x3e200
    buffer_load_dword v63, v8, s[40:43], s35 offen nt
    s_add_u32 s35, s56, 0x54000
    buffer_load_dword v64, v8, s[40:43], s35 offen nt
    s_add_u32 s35, s56, 0x54e00
    buffer_load_dword v65, v8, s[40:43], s35 offen nt
    s_add_u32 s35, s56, 0x55c00
    buffer_load_dword v66, v8, s[40:43], s35 offen nt
    s_add_u32 s35, s56, 0x56a00
    buffer_load_dword v67, v8, s[40:43], s35 offen nt
    s_add_u32 s35, s56, 0x57800
    buffer_load_dword v68, v8, s[40:43], s35 offen nt
    s_add_u32 s35, s56, 0x58600
    buffer_load_dword v69, v8, s[40:43], s35 offen nt
    s_add_u32 s35, s56, 0x59400
    buffer_load_dword v70, v8, s[40:43], s35 offen nt
    s_add_u32 s35, s56, 0x5a200
    buffer_load_dword v71, v8, s[40:43], s35 offen nt
    v_lshlrev_b32 v4, 13, v2
    v_lshl_add_u32 v4, v3, 4, v4
    s_lshl_b32 s56, s69, 15
    s_lshl_b32 s35, s33, 8
    s_add_u32 s56, s56, s35
    s_add_u32 s59, s56, 4096
    buffer_load_dwordx4 v[96:99], v4, s[44:47], s56 offen offset:0 nt
    buffer_load_dwordx4 v[100:103], v4, s[44:47], s56 offen offset:1024 nt
    buffer_load_dwordx4 v[104:107], v4, s[44:47], s56 offen offset:2048 nt
    buffer_load_dwordx4 v[108:111], v4, s[44:47], s56 offen offset:3072 nt
    buffer_load_dwordx4 v[112:115], v4, s[44:47], s59 offen offset:0 nt
    buffer_load_dwordx4 v[116:119], v4, s[44:47], s59 offen offset:1024 nt
    buffer_load_dwordx4 v[120:123], v4, s[44:47], s59 offen offset:2048 nt
    buffer_load_dwordx4 v[124:127], v4, s[44:47], s59 offen offset:3072 nt
    s_lshl_b32 s35, s33, 8
    s_add_u32 s35, s35, 64
    v_lshlrev_b32 v9, 2, v1
    v_add_u32 v9, s35, v9
    v_lshlrev_b32 v10, 4, v2
    v_add_u32 v10, s35, v10
    s_lshl_b32 s35, s33, 3
    v_mov_b32 v11, s35
    s_lshl_b32 s35, s33, 7
    s_add_u32 s35, s35, 2048
    v_lshlrev_b32 v12, 3, v3
    v_add_u32 v12, s35, v12
    v_and_b32 v4, 31, v1
    v_lshlrev_b32 v13, 2, v4
    v_add_u32 v13, 2048, v13
    s_lshl_b32 s35, s33, 6
    s_add_u32 s35, s35, 3328
    v_lshlrev_b32 v128, 1, v4
    v_add_u32 v128, s35, v128
    v_lshlrev_b32 v129, 4, v2
    v_add_u32 v129, s35, v129
    s_lshl_b32 s35, s33, 10
    v_lshlrev_b32 v130, 6, v3
    v_add_u32 v130, s35, v130
    s_waitcnt vmcnt(0)
    v_perm_b32 v32, v41, v40, s60
    v_perm_b32 v36, v41, v40, s61
    v_perm_b32 v33, v43, v42, s60
    v_perm_b32 v37, v43, v42, s61
    v_perm_b32 v34, v45, v44, s60
    v_perm_b32 v38, v45, v44, s61
    v_perm_b32 v35, v47, v46, s60
    v_perm_b32 v39, v47, v46, s61
    v_perm_b32 v40, v49, v48, s60
    v_perm_b32 v44, v49, v48, s61
    v_perm_b32 v41, v51, v50, s60
    v_perm_b32 v45, v51, v50, s61
    v_perm_b32 v42, v53, v52, s60
    v_perm_b32 v46, v53, v52, s61
    v_perm_b32 v43, v55, v54, s60
    v_perm_b32 v47, v55, v54, s61
    v_perm_b32 v48, v57, v56, s60
    v_perm_b32 v52, v57, v56, s61
    v_perm_b32 v49, v59, v58, s60
    v_perm_b32 v53, v59, v58, s61
    v_perm_b32 v50, v61, v60, s60
    v_perm_b32 v54, v61, v60, s61
    v_perm_b32 v51, v63, v62, s60
    v_perm_b32 v55, v63, v62, s61
    v_perm_b32 v56, v65, v64, s60
    v_perm_b32 v60, v65, v64, s61
    v_perm_b32 v57, v67, v66, s60
    v_perm_b32 v61, v67, v66, s61
    v_perm_b32 v58, v69, v68, s60
    v_perm_b32 v62, v69, v68, s61
    v_perm_b32 v59, v71, v70, s60
    v_perm_b32 v63, v71, v70, s61
    v_perm_b32 v64, v100, v96, s60
    v_perm_b32 v68, v100, v96, s61
    v_perm_b32 v65, v108, v104, s60
    v_perm_b32 v69, v108, v104, s61
    v_perm_b32 v66, v116, v112, s60
    v_perm_b32 v70, v116, v112, s61
    v_perm_b32 v67, v124, v120, s60
    v_perm_b32 v71, v124, v120, s61
    v_perm_b32 v72, v101, v97, s60
    v_perm_b32 v76, v101, v97, s61
    v_perm_b32 v73, v109, v105, s60
    v_perm_b32 v77, v109, v105, s61
    v_perm_b32 v74, v117, v113, s60
    v_perm_b32 v78, v117, v113, s61
    v_perm_b32 v75, v125, v121, s60
    v_perm_b32 v79, v125, v121, s61
    v_perm_b32 v80, v102, v98, s60
    v_perm_b32 v84, v102, v98, s61
    v_perm_b32 v81, v110, v106, s60
    v_perm_b32 v85, v110, v106, s61
    v_perm_b32 v82, v118, v114, s60
    v_perm_b32 v86, v118, v114, s61
    v_perm_b32 v83, v126, v122, s60
    v_perm_b32 v87, v126, v122, s61
    v_perm_b32 v88, v103, v99, s60
    v_perm_b32 v92, v103, v99, s61
    v_perm_b32 v89, v111, v107, s60
    v_perm_b32 v93, v111, v107, s61
    v_perm_b32 v90, v119, v115, s60
    v_perm_b32 v94, v119, v115, s61
    v_perm_b32 v91, v127, v123, s60
    v_perm_b32 v95, v127, v123, s61
    v_lshlrev_b32 v15, 16, v15
    s_mov_b32 s84, 0
    v_mov_b32 v22, 12292
    s_cmp_lg_u32 s33, 0
    s_nop 0
    s_cbranch_scc1 Lcw_64
    s_lshl_b32 s56, s31, 10
    s_add_u32 s56, s56, 0x60000
    v_lshlrev_b32 v20, 3, v1
    v_min_u32 v21, 14, v1
    v_lshlrev_b32 v21, 3, v21
    s_mov_b32 s34, 0
    s_nop 0
Lcwp_65:
    buffer_load_dwordx2 v[16:17], v20, s[36:39], s56 offen sc1
    buffer_load_dwordx2 v[18:19], v21, s[36:39], s56 offen offset:512 sc1
    s_waitcnt vmcnt(0)
    v_cmp_ne_u32 vcc, s30, v17
    v_cmp_ne_u32 s[70:71], s30, v19
    s_or_b64 vcc, vcc, s[70:71]
    s_nop 3
    s_cbranch_vccz Lcwd_66
    s_sleep 4
    s_add_u32 s34, s34, 1
    s_cmp_lt_u32 s34, 400000
    s_cbranch_scc1 Lcwp_65
Lcwd_66:
    s_getreg_b32 s35, hwreg(HW_REG_XCC_ID)
    v_cmp_ne_u32 vcc, s35, v16
    v_cmp_ne_u32 s[70:71], s35, v18
    s_or_b64 vcc, vcc, s[70:71]
    s_cmp_eq_u64 vcc, 0
    s_cselect_b32 s35, 1, 0
    s_cmp_lt_u32 s34, 400000
    s_cselect_b32 s35, s35, 0
    v_mov_b32 v16, s35
    ds_write_b32 v22, v16
    s_waitcnt lgkmcnt(0)
Lcw_64:
    s_barrier
    ds_read_b32 v16, v22
    s_waitcnt lgkmcnt(0)
    v_readfirstlane_b32 s84, v16
    s_mov_b32 s35, 0x3f803f80
    v_mov_b32 v96, s35
    v_mov_b32 v97, s35
    v_mov_b32 v98, s35
    v_mov_b32 v99, s35
    v_mov_b32 v100, s35
    v_mov_b32 v101, s35
    v_mov_b32 v102, s35
    v_mov_b32 v103, s35
    v_mov_b32 v104, s35
    v_mov_b32 v105, s35
    v_mov_b32 v106, s35
    v_mov_b32 v107, s35
    v_mov_b32 v108, s35
    v_mov_b32 v109, s35
    v_mov_b32 v110, s35
    v_mov_b32 v111, s35
    v_mfma_f32_16x16x32_bf16 v[112:115], v[96:99], v[32:35], 0
    v_mfma_f32_16x16x32_bf16 v[116:119], v[96:99], v[36:39], 0
    v_mfma_f32_16x16x32_bf16 v[112:115], v[100:103], v[40:43], v[112:115]
    v_mfma_f32_16x16x32_bf16 v[116:119], v[100:103], v[44:47], v[116:119]
    v_mfma_f32_16x16x32_bf16 v[112:115], v[104:107], v[48:51], v[112:115]
    v_mfma_f32_16x16x32_bf16 v[116:119], v[104:107], v[52:55], v[116:119]
    v_mfma_f32_16x16x32_bf16 v[112:115], v[108:111], v[56:59], v[112:115]
    v_mfma_f32_16x16x32_bf16 v[116:119], v[108:111], v[60:63], v[116:119]
    s_nop 7
    ds_write2_b32 v12, v112, v116 offset0:0 offset1:1
    s_waitcnt lgkmcnt(0)
    s_barrier
    ds_read_b32 v16, v13 offset:0
    ds_read_b32 v17, v13 offset:128
    ds_read_b32 v18, v13 offset:256
    ds_read_b32 v19, v13 offset:384
    s_waitcnt lgkmcnt(0)
    v_add_f32 v16, v16, v17
    v_add_f32 v18, v18, v19
    v_add_f32 v131, v16, v18
    s_nop 1
L_ffn_loop:
    s_lshl_b32 s57, s31, 7
    s_add_u32 s57, s57, s77
    s_add_u32 s57, s57, 0x52000
    s_cmp_lg_u32 s33, 0
    s_cbranch_scc1 Lgs_67
    s_mov_b32 s34, 0
    s_add_u32 s58, s57, 0x4000000
    s_cmp_lg_u32 s84, 0
    s_cselect_b32 s58, s57, s58
Lgp_68:
    s_and_b32 s35, s34, 15
    s_cmp_eq_u32 s35, 15
    s_cselect_b32 s56, s58, s57
    buffer_load_dword v16, off, s[36:39], s56 offset:4 sc1
    s_waitcnt vmcnt(0)
    v_readfirstlane_b32 s35, v16
    s_cmp_eq_u32 s35, s30
    s_nop 3
    s_cbranch_scc1 Lgs_67
    s_sleep 1
    s_add_u32 s34, s34, 1
    s_cmp_lt_u32 s34, s78
    s_cbranch_scc1 Lgp_68
Lgs_67:
    s_barrier
    s_and_b32 s74, s31, 7
    s_lshl_b32 s74, s74, 14
    s_add_u32 s74, s74, s77
    s_add_u32 s75, s74, 0xc1000
    s_add_u32 s74, s74, 0xc0000
    s_add_u32 s76, s77, 0x41000
    s_mov_b32 s34, 0
Lp_69:
    buffer_load_dwordx4 v[96:99], v7, s[36:39], s74 offen offset:0 sc1
    buffer_load_dwordx4 v[100:103], v7, s[36:39], s74 offen offset:2048 sc1
    buffer_load_dwordx4 v[104:107], v7, s[36:39], s75 offen offset:0 sc1
    buffer_load_dwordx4 v[108:111], v7, s[36:39], s75 offen offset:2048 sc1
    buffer_load_dwordx2 v[30:31], v6, s[36:39], s76 offen sc1
    s_waitcnt vmcnt(0)
    v_min3_u32 v16, v99, v103, v107
    v_max3_u32 v17, v99, v103, v107
    v_min3_u32 v16, v16, v111, v31
    v_max3_u32 v17, v17, v111, v31
    v_cmp_ne_u32 vcc, s30, v16
    v_cmp_ne_u32 s[70:71], s30, v17
    s_or_b64 vcc, vcc, s[70:71]
    s_nop 3
    s_cbranch_vccz Ld_70
    s_add_u32 s34, s34, 1
    s_cmp_lt_u32 s34, s78
    s_cbranch_scc1 Lp_69
Ld_70:
    v_perm_b32 v20, v97, v96, s72
    v_perm_b32 v21, v101, v100, s72
    v_perm_b32 v22, v105, v104, s72
    v_perm_b32 v23, v109, v108, s72
    v_perm_b32 v99, v98, v20, s73
    v_perm_b32 v103, v102, v21, s73
    v_perm_b32 v107, v106, v22, s73
    v_perm_b32 v111, v110, v23, s73
    v_add_f32 v96, v96, v100
    v_add_f32 v97, v97, v101
    v_add_f32 v98, v98, v102
    v_add_f32 v99, v99, v103
    v_add_f32 v104, v104, v108
    v_add_f32 v105, v105, v109
    v_add_f32 v106, v106, v110
    v_add_f32 v107, v107, v111
    v_add_f32 v96, v96, v104
    v_add_f32 v97, v97, v105
    v_add_f32 v98, v98, v106
    v_add_f32 v99, v99, v107
    v_cndmask_b32 v20, v98, v96, s[82:83]
    v_cndmask_b32 v21, v99, v97, s[82:83]
    v_cndmask_b32 v26, v96, v98, s[82:83]
    v_cndmask_b32 v27, v97, v99, s[82:83]
    s_nop 0
    v_add_f32_dpp v26, v20, v26 quad_perm:[1,0,3,2] row_mask:0xf bank_mask:0xf
    v_add_f32_dpp v27, v21, v27 quad_perm:[1,0,3,2] row_mask:0xf bank_mask:0xf
    v_cvt_pk_bf16_f32 v18, v26, v27
    v_lshlrev_b32 v26, 16, v18
    v_and_b32 v27, 0xffff0000, v18
    v_lshlrev_b32 v19, 16, v30
    v_and_b32 v20, 0xffff0000, v30
    v_add_f32 v26, v26, v19
    v_add_f32 v27, v27, v20
    v_cvt_pk_bf16_f32 v18, v26, v27
    v_lshlrev_b32 v26, 16, v18
    v_and_b32 v27, 0xffff0000, v18
    ds_write_b32 v9, v18
    v_add_f32 v20, v26, v27
    v_mul_f32 v21, v26, v26
    v_fmac_f32 v21, v27, v27
    s_waitcnt lgkmcnt(0)
    ds_read_b128 v[96:99], v10 offset:0
    ds_read_b128 v[100:103], v10 offset:64
    ds_read_b128 v[104:107], v10 offset:128
    ds_read_b128 v[108:111], v10 offset:192
    v_add_f32_dpp v20, v20, v20 row_ror:8 row_mask:0xf bank_mask:0xf
    v_add_f32_dpp v21, v21, v21 row_ror:8 row_mask:0xf bank_mask:0xf
    s_nop 0
    v_add_f32_dpp v20, v20, v20 row_ror:4 row_mask:0xf bank_mask:0xf
    v_add_f32_dpp v21, v21, v21 row_ror:4 row_mask:0xf bank_mask:0xf
    s_nop 0
    v_add_f32_dpp v20, v20, v20 row_ror:2 row_mask:0xf bank_mask:0xf
    v_add_f32_dpp v21, v21, v21 row_ror:2 row_mask:0xf bank_mask:0xf
    s_nop 0
    v_add_f32_dpp v20, v20, v20 row_ror:1 row_mask:0xf bank_mask:0xf
    v_add_f32_dpp v21, v21, v21 row_ror:1 row_mask:0xf bank_mask:0xf
    v_mov_b32 v22, v20
    v_mov_b32 v23, v21
    s_nop 0
    v_permlane16_swap_b32 v20, v22
    v_permlane16_swap_b32 v21, v23
    v_add_f32 v20, v20, v22
    v_add_f32 v21, v21, v23
    v_mov_b32 v22, v20
    v_mov_b32 v23, v21
    s_nop 0
    v_permlane32_swap_b32 v20, v22
    v_permlane32_swap_b32 v21, v23
    v_add_f32 v20, v20, v22
    v_add_f32 v21, v21, v23
    s_waitcnt lgkmcnt(0)
    v_mfma_f32_16x16x32_bf16 v[112:115], v[96:99], v[32:35], 0
    v_mfma_f32_16x16x32_bf16 v[116:119], v[96:99], v[36:39], 0
    v_mfma_f32_16x16x32_bf16 v[112:115], v[100:103], v[40:43], v[112:115]
    v_mfma_f32_16x16x32_bf16 v[116:119], v[100:103], v[44:47], v[116:119]
    v_mfma_f32_16x16x32_bf16 v[112:115], v[104:107], v[48:51], v[112:115]
    v_mfma_f32_16x16x32_bf16 v[116:119], v[104:107], v[52:55], v[116:119]
    v_mfma_f32_16x16x32_bf16 v[112:115], v[108:111], v[56:59], v[112:115]
    v_mfma_f32_16x16x32_bf16 v[116:119], v[108:111], v[60:63], v[116:119]
    s_nop 7
    ds_write2_b32 v12, v112, v116 offset0:0 offset1:1
    ds_write_b64 v11, v[20:21]
    s_cmp_lg_u32 s69, 0
    s_cbranch_scc1 Lxb_71
    v_mov_b32 v30, v18
    v_mov_b32 v31, s30
    s_add_u32 s56, s77, 0x40000
    buffer_store_dwordx2 v[30:31], v6, s[36:39], s56 offen sc1
Lxb_71:
    s_lshl_b32 s56, s31, 15
    s_add_u32 s56, s56, s77
    s_add_u32 s56, s56, s68
    s_add_u32 s56, s56, 0x80000
    s_add_u32 s59, s56, 0x4000000
    v_mov_b32 v25, 0
    s_waitcnt lgkmcnt(0)
    s_nop 0
    s_barrier
    ds_read_b128 v[96:99], v25 offset:0
    ds_read_b128 v[100:103], v25 offset:16
    ds_read_b32 v16, v13 offset:0
    ds_read_b32 v17, v13 offset:128
    ds_read_b32 v18, v13 offset:256
    ds_read_b32 v19, v13 offset:384
    s_waitcnt lgkmcnt(0)
    v_add_f32 v96, v96, v98
    v_add_f32 v97, v97, v99
    v_add_f32 v100, v100, v102
    v_add_f32 v101, v101, v103
    v_add_f32 v96, v96, v100
    v_add_f32 v97, v97, v101
    v_add_f32 v16, v16, v17
    v_add_f32 v18, v18, v19
    v_add_f32 v16, v16, v18
    v_mul_f32 v96, 0x3b000000, v96
    v_mul_f32 v97, 0x3b000000, v97
    v_fma_f32 v97, -v96, v96, v97
    v_max_f32 v97, 0, v97
    v_cvt_pk_bf16_f32 v98, v96, v97
    v_lshlrev_b32 v96, 16, v98
    v_and_b32 v97, 0xffff0000, v98
    v_add_f32 v97, 0x3727c5ac, v97
    v_cvt_pk_bf16_f32 v97, v97, v97
    v_lshlrev_b32 v97, 16, v97
    v_sqrt_f32 v97, v97
    s_nop 0
    v_cvt_pk_bf16_f32 v97, v97, v97
    v_lshlrev_b32 v97, 16, v97
    v_rcp_f32 v97, v97
    v_fma_f32 v16, -v96, v131, v16
    v_mul_f32 v16, v16, v97
    v_cvt_pk_bf16_f32 v16, v16, v16
    v_lshlrev_b32 v16, 16, v16
    v_add_f32 v16, v16, v15
    v_cvt_pk_bf16_f32 v16, v16, v16
    v_lshlrev_b32 v16, 16, v16
    v_mul_f32 v17, v16, v16
    v_mul_f32 v17, 0x3d372713, v17
    v_fma_f32 v17, v17, v16, v16
    v_mul_f32 v17, 0xc0135761, v17
    v_exp_f32 v17, v17
    s_nop 0
    v_add_f32 v17, 1.0, v17
    v_rcp_f32 v17, v17
    s_nop 0
    v_mul_f32 v16, v16, v17
    v_cvt_pk_bf16_f32 v16, v16, v16
    ds_write_b16 v128, v16
    s_waitcnt lgkmcnt(0)
    ds_read_b128 v[20:23], v129
    s_waitcnt lgkmcnt(0)
    v_mfma_f32_16x16x32_bf16 v[96:99], v[20:23], v[64:67], 0
    v_mfma_f32_16x16x32_bf16 v[100:103], v[20:23], v[68:71], 0
    v_mfma_f32_16x16x32_bf16 v[104:107], v[20:23], v[72:75], 0
    v_mfma_f32_16x16x32_bf16 v[108:111], v[20:23], v[76:79], 0
    v_mfma_f32_16x16x32_bf16 v[112:115], v[20:23], v[80:83], 0
    v_mfma_f32_16x16x32_bf16 v[116:119], v[20:23], v[84:87], 0
    v_mfma_f32_16x16x32_bf16 v[120:123], v[20:23], v[88:91], 0
    v_mfma_f32_16x16x32_bf16 v[124:127], v[20:23], v[92:95], 0
    s_mov_b64 exec, 0xffff
    s_nop 0
    v_mov_b32 v98, v100
    v_mov_b32 v97, s30
    v_mov_b32 v99, s30
    buffer_store_dwordx4 v[96:99], v130, s[36:39], s56 offen offset:0
    v_mov_b32 v106, v108
    v_mov_b32 v105, s30
    v_mov_b32 v107, s30
    buffer_store_dwordx4 v[104:107], v130, s[36:39], s56 offen offset:16
    v_mov_b32 v114, v116
    v_mov_b32 v113, s30
    v_mov_b32 v115, s30
    buffer_store_dwordx4 v[112:115], v130, s[36:39], s56 offen offset:32
    v_mov_b32 v122, v124
    v_mov_b32 v121, s30
    v_mov_b32 v123, s30
    buffer_store_dwordx4 v[120:123], v130, s[36:39], s56 offen offset:48
    s_cmp_lg_u32 s84, 0
    s_nop 0
    s_cbranch_scc1 Lug_72
    buffer_store_dwordx4 v[96:99], v130, s[36:39], s59 offen offset:0 sc1
    buffer_store_dwordx4 v[104:107], v130, s[36:39], s59 offen offset:16 sc1
    buffer_store_dwordx4 v[112:115], v130, s[36:39], s59 offen offset:32 sc1
    buffer_store_dwordx4 v[120:123], v130, s[36:39], s59 offen offset:48 sc1
    s_nop 1
Lug_72:
    s_mov_b64 exec, -1
    s_cmp_lg_u32 s78, 0
    s_cbranch_scc1 Lt_73
    s_mov_b32 s77, 0x0
    s_mov_b32 s78, 400000
    s_branch L_ffn_loop
Lt_73:
    s_bitcmp0_b32 s30, 0
    s_cbranch_scc1 L_end
    s_add_u32 s30, s30, 1
    s_branch L_ffn_loop
L_end:
    s_endpgm
.section .rodata,"a"
.p2align 6
.amdhsa_kernel interleave_layers__sliding_block_cached__dense_activation_gelu__decode_kernel
  .amdhsa_next_free_vgpr 144
  .amdhsa_next_free_sgpr 88
  .amdhsa_accum_offset 144
  .amdhsa_group_segment_fixed_size 0
  .amdhsa_kernarg_size 104
  .amdhsa_user_sgpr_count 2
  .amdhsa_user_sgpr_kernarg_segment_ptr 1
  .amdhsa_system_sgpr_workgroup_id_x 1
.end_amdhsa_kernel
```
